```python
import torch

def _softmax(x, axis=-1):
    return torch.softmax(x, dim=axis)
def _gelu(x):
    return torch.nn.functional.gelu(x, approximate="tanh")
def _silu(x):
    return torch.nn.functional.silu(x)
def _sigmoid(x):
    return torch.sigmoid(x)
def _layernorm(x, axis=-1, eps=1e-5):
    m = x.mean(dim=axis, keepdim=True)
    v = x.var(dim=axis, keepdim=True, unbiased=False)
    return (x - m) / torch.sqrt(v + eps)
def _scatter_add(tgt, idx, src, axis=0):
    return tgt.clone().index_add_(axis, idx, src)
def _segment_sum(src, seg, n):
    out = torch.zeros((n,) + src.shape[1:], dtype=src.dtype)
    return out.index_add_(0, seg, src)
def _pad(x, pw):
    flat = tuple(v for pair in reversed(pw) for v in pair)
    return torch.nn.functional.pad(x, flat)

kernel_name = 'parallel_sum__gqa_block_cached__dense_activation_squared_relu__decode'

def setup_inputs():

    _w = (lambda a: (lambda t: t.to(torch.bfloat16) if t.is_floating_point() else t)(torch.as_tensor(a)))
    def _A_setup():
        B, Sq, D = 4, 1, 640
        Hq, Hkv, Sk, Dh = 32, 32, 8192, 192
        assert Hq % Hkv == 0, (Hq, Hkv)
        return {
            "x": _w((lambda *s: torch.randn(*s, dtype=torch.bfloat16) * 0.05)(B, Sq, D)),
            "k_cache": _w((lambda *s: torch.randn(*s, dtype=torch.bfloat16) * 1.6)(B, Hkv, Sk, Dh)),
            "v_cache": _w((lambda *s: torch.randn(*s, dtype=torch.bfloat16) * 3.2)(B, Hkv, Sk, Dh)),
            "wq": _w((lambda *s: torch.randn(*s, dtype=torch.bfloat16) * 1.6)(D, Hq * Dh) * (D ** -0.5)),
            "wo": _w((lambda *s: torch.randn(*s, dtype=torch.bfloat16) * 3.2)(Hq * Dh, D) * ((Hq * Dh) ** -0.5)),
        }
    _A_in = _A_setup()

    def _B_setup():
        B, S, D, F = 4, 1, 640, 1536
        return {
            "x": _w((lambda *s: torch.randn(*s, dtype=torch.bfloat16) * 0.05)(B, S, D)),
            "w1": _w((lambda *s: torch.randn(*s, dtype=torch.bfloat16) * 0.05)(D, F)),
            "b1": _w((lambda *s: torch.randn(*s, dtype=torch.bfloat16) * 0.2)(F)),
            "w2": _w((lambda *s: torch.randn(*s, dtype=torch.bfloat16) * 0.05)(F, D)),
            "b2": _w((lambda *s: torch.randn(*s, dtype=torch.bfloat16) * 0.8)(D)),
        }
    _B_in = _B_setup()

    return {
        "A_x": _A_in["x"],
        "A_k_cache": _A_in["k_cache"],
        "A_v_cache": _A_in["v_cache"],
        "A_wq": _A_in["wq"],
        "A_wo": _A_in["wo"],
        "B_x": _B_in["x"],
        "B_w1": _B_in["w1"],
        "B_b1": _B_in["b1"],
        "B_w2": _B_in["w2"],
        "B_b2": _B_in["b2"],
    }

def reference(A_x, A_k_cache, A_v_cache, A_wq, A_wo, B_x, B_w1, B_b1, B_w2, B_b2):
    def _A_ref(x, k_cache, v_cache, wq, wo):
        B, Sq, D = x.shape
        Hq, Dh = 32, 192
        Hkv = k_cache.shape[1]
        rep = Hq // Hkv
        q = (lambda x, *d: x.permute(*d))((x @ wq).reshape(B, Sq, Hq, Dh), 0, 2, 1, 3)
        k = (lambda x, n, axis: torch.repeat_interleave(x, n, dim=axis))(k_cache, rep, axis=1)
        v = (lambda x, n, axis: torch.repeat_interleave(x, n, dim=axis))(v_cache, rep, axis=1)
        scores = torch.einsum("bhqd,bhkd->bhqk", q, k) * (Dh ** -0.5)
        p = _softmax(scores, axis=-1)
        o = torch.einsum("bhqk,bhkd->bhqd", p, v)
        return (lambda x, *d: x.permute(*d))(o, 0, 2, 1, 3).reshape(B, Sq, Hq * Dh) @ wo

    def _B_ref(x, w1, b1, w2, b2):
        h = torch.einsum("bsd,df->bsf", x, w1) + b1
        zero = torch.zeros_like(h)
        r = torch.where(h > zero, h, zero)
        h = r * r
        out = torch.einsum("bsf,fd->bsd", h, w2) + b2
        return out

    x = A_x
    xn = _layernorm(x, axis=-1)
    return x + _A_ref(xn, A_k_cache, A_v_cache, A_wq, A_wo) + _B_ref(xn, B_w1, B_b1, B_w2, B_b2)
```

```asm
; @launch grid=(256,1,1) block=(512,1,1) lds=112640
.amdgcn_target "amdgcn-amd-amdhsa--gfx950"
.text
.globl parallel_sum__gqa_block_cached__dense_activation_squared_relu__decode_kernel
.p2align 8
.type parallel_sum__gqa_block_cached__dense_activation_squared_relu__decode_kernel,@function
parallel_sum__gqa_block_cached__dense_activation_squared_relu__decode_kernel:
  s_cmp_ge_u32 s2, 256
  s_cbranch_scc1 L_end
  s_load_dwordx16 s[16:31], s[0:1], 0
  s_load_dwordx8 s[32:39], s[0:1], 64
  s_load_dwordx2 s[40:41], s[0:1], 96
  v_and_b32 v1, 63, v0
  v_lshrrev_b32 v3, 6, v0
  s_mov_b32 s15, 0xffff0000
  v_readfirstlane_b32 s3, v3
  s_lshr_b32 s4, s2, 3
  s_and_b32 s5, s2, 7
  s_cmp_ge_u32 s3, 4
  s_cbranch_scc1 L_stream
  s_setprio 3
  v_lshrrev_b32 v3, 3, v1
  v_and_b32 v4, 7, v1
  s_cmp_eq_u32 s3, 3
  s_movk_i32 s8, 3072
  s_cselect_b32 s8, s8, 12288
  v_mul_lo_u32 v2, v3, s8
  v_lshl_add_u32 v2, v4, 4, v2
  s_mul_i32 s84, s5, 80
  s_mul_i32 s84, s84, s8
  s_lshl_b32 s11, s8, 3
  s_mul_i32 s9, s4, 384
  s_lshl_b32 s10, s3, 7
  s_add_u32 s9, s9, s10
  s_min_u32 s10, s4, 23
  s_lshl_b32 s10, s10, 7
  s_cmp_eq_u32 s3, 3
  s_cselect_b32 s9, s10, s9
  s_add_u32 s84, s84, s9
  v_lshrrev_b32 v3, 4, v1
  v_mul_u32_u24 v3, 1280, v3
  v_and_b32 v4, 15, v1
  v_lshl_add_u32 v5, v4, 4, v3
  v_lshl_add_u32 v8, v4, 3, s10
  v_min_u32 v4, 9, v4
  v_lshl_add_u32 v6, v4, 4, v3
  s_mul_i32 s9, s5, 160
  v_add_u32 v6, s9, v6
  v_mov_b32 v7, 1
  v_mov_b32 v84, 0
  v_mov_b32 v85, 0
  v_mov_b32 v86, 0
  v_mov_b32 v87, 0
  v_mov_b32 v88, 0
  v_mov_b32 v89, 0
  v_mov_b32 v90, 0
  v_mov_b32 v91, 0
  v_mov_b32 v92, 0
  v_mov_b32 v93, 0
  v_mov_b32 v94, 0
  v_mov_b32 v95, 0
  v_mov_b32 v96, 0
  v_mov_b32 v97, 0
  v_mov_b32 v98, 0
  v_mov_b32 v99, 0
  v_mov_b32 v100, 0
  v_mov_b32 v101, 0
  v_mov_b32 v102, 0
  v_mov_b32 v103, 0
  v_mov_b32 v104, 0
  v_mov_b32 v105, 0
  v_mov_b32 v106, 0
  v_mov_b32 v107, 0
  v_mov_b32 v108, 0
  v_mov_b32 v109, 0
  v_mov_b32 v110, 0
  v_mov_b32 v111, 0
  v_mov_b32 v112, 0
  v_mov_b32 v113, 0
  v_mov_b32 v114, 0
  v_mov_b32 v115, 0
  v_and_b32 v3, 15, v1
  v_lshlrev_b32 v3, 2, v3
  ds_write_b32 v3, v84 offset:2048
  s_cmp_lt_u32 s4, 24
  s_cselect_b32 s82, 1966080, 0
  s_waitcnt lgkmcnt(0)
  s_load_dword s78, s[40:41], 0
  global_load_dwordx4 v[20:23], v5, s[16:17] offset:0
  global_load_dwordx4 v[24:27], v5, s[16:17] offset:256
  global_load_dwordx4 v[28:31], v5, s[16:17] offset:512
  global_load_dwordx4 v[32:35], v5, s[16:17] offset:768
  global_load_dwordx4 v[36:39], v5, s[16:17] offset:1024
  global_load_dwordx4 v[40:43], v6, s[16:17]
  s_cmp_eq_u32 s3, 3
  s_cselect_b32 s80, s28, s22
  s_cselect_b32 s81, s29, s23
  s_cselect_b32 s82, s82, 7864320
  s_mov_b32 s83, 0x20000
  buffer_load_dwordx4 v[116:119], v2, s[80:83], s84 offen nt
  s_add_u32 s84, s84, s11
  buffer_load_dwordx4 v[120:123], v2, s[80:83], s84 offen nt
  s_add_u32 s84, s84, s11
  buffer_load_dwordx4 v[124:127], v2, s[80:83], s84 offen nt
  s_add_u32 s84, s84, s11
  buffer_load_dwordx4 v[128:131], v2, s[80:83], s84 offen nt
  s_add_u32 s84, s84, s11
  buffer_load_dwordx4 v[132:135], v2, s[80:83], s84 offen nt
  s_add_u32 s84, s84, s11
  buffer_load_dwordx4 v[136:139], v2, s[80:83], s84 offen nt
  s_add_u32 s84, s84, s11
  buffer_load_dwordx4 v[140:143], v2, s[80:83], s84 offen nt
  s_add_u32 s84, s84, s11
  buffer_load_dwordx4 v[144:147], v2, s[80:83], s84 offen nt
  s_add_u32 s84, s84, s11
  buffer_load_dwordx4 v[148:151], v2, s[80:83], s84 offen nt
  s_add_u32 s84, s84, s11
  buffer_load_dwordx4 v[152:155], v2, s[80:83], s84 offen nt
  global_load_dwordx2 v[204:205], v8, s[30:31]
  s_mul_i32 s95, s4, 40960
  s_add_u32 s95, s95, 3145728
  s_mul_i32 s8, s4, 4352
  s_add_u32 s8, s8, 8388608
  v_mov_b32 v3, s8
  s_or_b32 s8, s5, s3
  s_cmp_eq_u32 s8, 0
  s_cbranch_scc0 L_noq
  s_mov_b64 exec, 1
  global_store_dword v3, v84, s[40:41] sc1
  s_mov_b64 exec, -1
L_noq:
  s_waitcnt vmcnt(11)
  v_lshlrev_b32 v44, 16, v20
  v_and_b32 v45, s15, v20
  v_lshlrev_b32 v46, 16, v21
  v_and_b32 v47, s15, v21
  v_lshlrev_b32 v48, 16, v22
  v_and_b32 v49, s15, v22
  v_lshlrev_b32 v50, 16, v23
  v_and_b32 v51, s15, v23
  v_lshlrev_b32 v52, 16, v24
  v_and_b32 v53, s15, v24
  v_lshlrev_b32 v54, 16, v25
  v_and_b32 v55, s15, v25
  v_lshlrev_b32 v56, 16, v26
  v_and_b32 v57, s15, v26
  v_lshlrev_b32 v58, 16, v27
  v_and_b32 v59, s15, v27
  v_lshlrev_b32 v60, 16, v28
  v_and_b32 v61, s15, v28
  v_lshlrev_b32 v62, 16, v29
  v_and_b32 v63, s15, v29
  v_lshlrev_b32 v64, 16, v30
  v_and_b32 v65, s15, v30
  v_lshlrev_b32 v66, 16, v31
  v_and_b32 v67, s15, v31
  v_lshlrev_b32 v68, 16, v32
  v_and_b32 v69, s15, v32
  v_lshlrev_b32 v70, 16, v33
  v_and_b32 v71, s15, v33
  v_lshlrev_b32 v72, 16, v34
  v_and_b32 v73, s15, v34
  v_lshlrev_b32 v74, 16, v35
  v_and_b32 v75, s15, v35
  v_lshlrev_b32 v76, 16, v36
  v_and_b32 v77, s15, v36
  v_lshlrev_b32 v78, 16, v37
  v_and_b32 v79, s15, v37
  v_lshlrev_b32 v80, 16, v38
  v_and_b32 v81, s15, v38
  v_lshlrev_b32 v82, 16, v39
  v_and_b32 v83, s15, v39
  v_pk_add_f32 v[8:9], v[44:45], v[46:47]
  v_pk_add_f32 v[10:11], v[48:49], v[50:51]
  v_pk_add_f32 v[8:9], v[8:9], v[52:53]
  v_pk_add_f32 v[10:11], v[10:11], v[54:55]
  v_pk_add_f32 v[8:9], v[8:9], v[56:57]
  v_pk_add_f32 v[10:11], v[10:11], v[58:59]
  v_pk_add_f32 v[8:9], v[8:9], v[60:61]
  v_pk_add_f32 v[10:11], v[10:11], v[62:63]
  v_pk_add_f32 v[8:9], v[8:9], v[64:65]
  v_pk_add_f32 v[10:11], v[10:11], v[66:67]
  v_pk_add_f32 v[8:9], v[8:9], v[68:69]
  v_pk_add_f32 v[10:11], v[10:11], v[70:71]
  v_pk_add_f32 v[8:9], v[8:9], v[72:73]
  v_pk_add_f32 v[10:11], v[10:11], v[74:75]
  v_pk_add_f32 v[8:9], v[8:9], v[76:77]
  v_pk_add_f32 v[10:11], v[10:11], v[78:79]
  v_pk_add_f32 v[8:9], v[8:9], v[80:81]
  v_pk_add_f32 v[10:11], v[10:11], v[82:83]
  v_pk_add_f32 v[8:9], v[8:9], v[10:11]
  v_add_f32 v8, v8, v9
  s_nop 1
  v_add_f32_dpp v8, v8, v8 quad_perm:[1,0,3,2] row_mask:0xf bank_mask:0xf
  s_nop 1
  v_add_f32_dpp v8, v8, v8 quad_perm:[2,3,0,1] row_mask:0xf bank_mask:0xf
  s_nop 1
  v_add_f32_dpp v8, v8, v8 row_half_mirror row_mask:0xf bank_mask:0xf
  s_nop 1
  v_add_f32_dpp v8, v8, v8 row_mirror row_mask:0xf bank_mask:0xf
  v_mul_f32 v8, -0.0015625, v8
  v_pk_add_f32 v[44:45], v[44:45], v[8:9] op_sel_hi:[1,0]
  v_pk_add_f32 v[46:47], v[46:47], v[8:9] op_sel_hi:[1,0]
  v_pk_add_f32 v[48:49], v[48:49], v[8:9] op_sel_hi:[1,0]
  v_pk_add_f32 v[50:51], v[50:51], v[8:9] op_sel_hi:[1,0]
  v_pk_add_f32 v[52:53], v[52:53], v[8:9] op_sel_hi:[1,0]
  v_pk_add_f32 v[54:55], v[54:55], v[8:9] op_sel_hi:[1,0]
  v_pk_add_f32 v[56:57], v[56:57], v[8:9] op_sel_hi:[1,0]
  v_pk_add_f32 v[58:59], v[58:59], v[8:9] op_sel_hi:[1,0]
  v_pk_add_f32 v[60:61], v[60:61], v[8:9] op_sel_hi:[1,0]
  v_pk_add_f32 v[62:63], v[62:63], v[8:9] op_sel_hi:[1,0]
  v_pk_add_f32 v[64:65], v[64:65], v[8:9] op_sel_hi:[1,0]
  v_pk_add_f32 v[66:67], v[66:67], v[8:9] op_sel_hi:[1,0]
  v_pk_add_f32 v[68:69], v[68:69], v[8:9] op_sel_hi:[1,0]
  v_pk_add_f32 v[70:71], v[70:71], v[8:9] op_sel_hi:[1,0]
  v_pk_add_f32 v[72:73], v[72:73], v[8:9] op_sel_hi:[1,0]
  v_pk_add_f32 v[74:75], v[74:75], v[8:9] op_sel_hi:[1,0]
  v_pk_add_f32 v[76:77], v[76:77], v[8:9] op_sel_hi:[1,0]
  v_pk_add_f32 v[78:79], v[78:79], v[8:9] op_sel_hi:[1,0]
  v_pk_add_f32 v[80:81], v[80:81], v[8:9] op_sel_hi:[1,0]
  v_pk_add_f32 v[82:83], v[82:83], v[8:9] op_sel_hi:[1,0]
  v_pk_mul_f32 v[10:11], v[44:45], v[44:45]
  v_pk_mul_f32 v[12:13], v[46:47], v[46:47]
  v_pk_fma_f32 v[10:11], v[48:49], v[48:49], v[10:11]
  v_pk_fma_f32 v[12:13], v[50:51], v[50:51], v[12:13]
  v_pk_fma_f32 v[10:11], v[52:53], v[52:53], v[10:11]
  v_pk_fma_f32 v[12:13], v[54:55], v[54:55], v[12:13]
  v_pk_fma_f32 v[10:11], v[56:57], v[56:57], v[10:11]
  v_pk_fma_f32 v[12:13], v[58:59], v[58:59], v[12:13]
  v_pk_fma_f32 v[10:11], v[60:61], v[60:61], v[10:11]
  v_pk_fma_f32 v[12:13], v[62:63], v[62:63], v[12:13]
  v_pk_fma_f32 v[10:11], v[64:65], v[64:65], v[10:11]
  v_pk_fma_f32 v[12:13], v[66:67], v[66:67], v[12:13]
  v_pk_fma_f32 v[10:11], v[68:69], v[68:69], v[10:11]
  v_pk_fma_f32 v[12:13], v[70:71], v[70:71], v[12:13]
  v_pk_fma_f32 v[10:11], v[72:73], v[72:73], v[10:11]
  v_pk_fma_f32 v[12:13], v[74:75], v[74:75], v[12:13]
  v_pk_fma_f32 v[10:11], v[76:77], v[76:77], v[10:11]
  v_pk_fma_f32 v[12:13], v[78:79], v[78:79], v[12:13]
  v_pk_fma_f32 v[10:11], v[80:81], v[80:81], v[10:11]
  v_pk_fma_f32 v[12:13], v[82:83], v[82:83], v[12:13]
  v_pk_add_f32 v[10:11], v[10:11], v[12:13]
  v_add_f32 v10, v10, v11
  s_nop 1
  v_add_f32_dpp v10, v10, v10 quad_perm:[1,0,3,2] row_mask:0xf bank_mask:0xf
  s_nop 1
  v_add_f32_dpp v10, v10, v10 quad_perm:[2,3,0,1] row_mask:0xf bank_mask:0xf
  s_nop 1
  v_add_f32_dpp v10, v10, v10 row_half_mirror row_mask:0xf bank_mask:0xf
  s_nop 1
  v_add_f32_dpp v10, v10, v10 row_mirror row_mask:0xf bank_mask:0xf
  v_mul_f32 v10, 0.0015625, v10
  v_cvt_pk_bf16_f32 v9, v8, v10
  v_lshlrev_b32 v8, 16, v9
  v_and_b32 v10, s15, v9
  v_add_f32 v10, 0x3727c5ac, v10
  v_cvt_pk_bf16_f32 v9, v10, v10
  v_lshlrev_b32 v10, 16, v9
  v_sqrt_f32 v10, v10
  s_waitcnt lgkmcnt(0)
  v_lshlrev_b32 v156, 16, v40
  v_and_b32 v157, s15, v40
  v_lshlrev_b32 v158, 16, v41
  v_and_b32 v159, s15, v41
  v_lshlrev_b32 v160, 16, v42
  v_and_b32 v161, s15, v42
  v_lshlrev_b32 v162, 16, v43
  v_and_b32 v163, s15, v43
  v_cvt_pk_bf16_f32 v9, v10, v10
  v_lshlrev_b32 v10, 16, v9
  v_rcp_f32 v11, v10
  v_add_f32 v156, v156, v8
  v_add_f32 v157, v157, v8
  v_add_f32 v158, v158, v8
  v_add_f32 v159, v159, v8
  v_add_f32 v160, v160, v8
  v_add_f32 v161, v161, v8
  v_add_f32 v162, v162, v8
  v_add_f32 v163, v163, v8
  v_cvt_pk_bf16_f32 v9, v156, v157
  v_lshlrev_b32 v156, 16, v9
  v_and_b32 v157, s15, v9
  v_cvt_pk_bf16_f32 v9, v158, v159
  v_lshlrev_b32 v158, 16, v9
  v_and_b32 v159, s15, v9
  v_cvt_pk_bf16_f32 v9, v160, v161
  v_lshlrev_b32 v160, 16, v9
  v_and_b32 v161, s15, v9
  v_cvt_pk_bf16_f32 v9, v162, v163
  v_lshlrev_b32 v162, 16, v9
  v_and_b32 v163, s15, v9
  v_mul_f32 v12, v156, v11
  v_fma_f32 v13, -v12, v10, v156
  v_fma_f32 v156, v13, v11, v12
  v_mul_f32 v12, v157, v11
  v_fma_f32 v13, -v12, v10, v157
  v_fma_f32 v157, v13, v11, v12
  v_mul_f32 v12, v158, v11
  v_fma_f32 v13, -v12, v10, v158
  v_fma_f32 v158, v13, v11, v12
  v_mul_f32 v12, v159, v11
  v_fma_f32 v13, -v12, v10, v159
  v_fma_f32 v159, v13, v11, v12
  v_mul_f32 v12, v160, v11
  v_fma_f32 v13, -v12, v10, v160
  v_fma_f32 v160, v13, v11, v12
  v_mul_f32 v12, v161, v11
  v_fma_f32 v13, -v12, v10, v161
  v_fma_f32 v161, v13, v11, v12
  v_mul_f32 v12, v162, v11
  v_fma_f32 v13, -v12, v10, v162
  v_fma_f32 v162, v13, v11, v12
  v_mul_f32 v12, v163, v11
  v_fma_f32 v13, -v12, v10, v163
  v_fma_f32 v163, v13, v11, v12
  v_cvt_pk_bf16_f32 v9, v156, v157
  v_lshlrev_b32 v156, 16, v9
  v_and_b32 v157, s15, v9
  v_cvt_pk_bf16_f32 v9, v158, v159
  v_lshlrev_b32 v158, 16, v9
  v_and_b32 v159, s15, v9
  v_cvt_pk_bf16_f32 v9, v160, v161
  v_lshlrev_b32 v160, 16, v9
  v_and_b32 v161, s15, v9
  v_cvt_pk_bf16_f32 v9, v162, v163
  v_lshlrev_b32 v162, 16, v9
  v_and_b32 v163, s15, v9
  s_mul_i32 s8, s3, 1280
  v_and_b32 v4, 15, v1
  v_min_u32 v4, 9, v4
  v_lshl_add_u32 v4, v4, 7, s8
  v_lshrrev_b32 v3, 4, v1
  v_lshl_add_u32 v4, v3, 2, v4
  ds_write_b32 v4, v156 offset:20480
  ds_write_b32 v4, v157 offset:20496
  ds_write_b32 v4, v158 offset:20512
  ds_write_b32 v4, v159 offset:20528
  ds_write_b32 v4, v160 offset:20544
  ds_write_b32 v4, v161 offset:20560
  ds_write_b32 v4, v162 offset:20576
  ds_write_b32 v4, v163 offset:20592
  v_lshrrev_b32 v3, 3, v1
  v_lshl_add_u32 v3, v3, 4, s8
  s_add_u32 s78, s78, 1
  s_addc_u32 s78, s78, 0
  s_cmp_eq_u32 s78, 0x80000001
  s_addc_u32 s78, s78, 0
  s_xor_b32 s94, s78, 0x80000001
  ds_read_b128 v[44:47], v3 offset:20480
  ds_read_b128 v[48:51], v3 offset:20608
  ds_read_b128 v[52:55], v3 offset:20736
  ds_read_b128 v[56:59], v3 offset:20864
  ds_read_b128 v[60:63], v3 offset:20992
  ds_read_b128 v[64:67], v3 offset:21120
  ds_read_b128 v[68:71], v3 offset:21248
  ds_read_b128 v[72:75], v3 offset:21376
  ds_read_b128 v[76:79], v3 offset:21504
  ds_read_b128 v[80:83], v3 offset:21632
  v_and_b32 v3, 7, v1
  v_bfe_u32 v4, v1, 3, 1
  v_lshl_add_u32 v3, v3, 1, v4
  s_lshl_b32 s8, s3, 4
  v_add_u32 v3, s8, v3
  v_lshrrev_b32 v4, 4, v1
  v_lshl_add_u32 v3, v4, 6, v3
  s_lshl_b32 s8, s5, 12
  s_add_u32 s8, s8, s95
  s_lshl_b32 s9, s5, 10
  s_lshl_b32 s10, s3, 8
  s_add_u32 s9, s9, s10
  s_add_u32 s9, s9, s95
  s_add_u32 s9, s9, 32768
  v_lshl_add_u32 v5, v3, 4, s8
  v_lshl_add_u32 v6, v1, 2, s9
  s_waitcnt vmcnt(10) lgkmcnt(9)
  v_lshlrev_b32 v16, 16, v116
  v_and_b32 v17, s15, v116
  v_pk_fma_f32 v[84:85], v[16:17], v[44:45], v[84:85] op_sel_hi:[1,0,1]
  v_pk_fma_f32 v[92:93], v[16:17], v[44:45], v[92:93] op_sel:[0,1,0] op_sel_hi:[1,1,1]
  v_pk_fma_f32 v[100:101], v[16:17], v[46:47], v[100:101] op_sel_hi:[1,0,1]
  v_pk_fma_f32 v[108:109], v[16:17], v[46:47], v[108:109] op_sel:[0,1,0] op_sel_hi:[1,1,1]
  v_lshlrev_b32 v18, 16, v117
  v_and_b32 v19, s15, v117
  v_pk_fma_f32 v[86:87], v[18:19], v[44:45], v[86:87] op_sel_hi:[1,0,1]
  v_pk_fma_f32 v[94:95], v[18:19], v[44:45], v[94:95] op_sel:[0,1,0] op_sel_hi:[1,1,1]
  v_pk_fma_f32 v[102:103], v[18:19], v[46:47], v[102:103] op_sel_hi:[1,0,1]
  v_pk_fma_f32 v[110:111], v[18:19], v[46:47], v[110:111] op_sel:[0,1,0] op_sel_hi:[1,1,1]
  v_lshlrev_b32 v16, 16, v118
  v_and_b32 v17, s15, v118
  v_pk_fma_f32 v[88:89], v[16:17], v[44:45], v[88:89] op_sel_hi:[1,0,1]
  v_pk_fma_f32 v[96:97], v[16:17], v[44:45], v[96:97] op_sel:[0,1,0] op_sel_hi:[1,1,1]
  v_pk_fma_f32 v[104:105], v[16:17], v[46:47], v[104:105] op_sel_hi:[1,0,1]
  v_pk_fma_f32 v[112:113], v[16:17], v[46:47], v[112:113] op_sel:[0,1,0] op_sel_hi:[1,1,1]
  v_lshlrev_b32 v18, 16, v119
  v_and_b32 v19, s15, v119
  v_pk_fma_f32 v[90:91], v[18:19], v[44:45], v[90:91] op_sel_hi:[1,0,1]
  v_pk_fma_f32 v[98:99], v[18:19], v[44:45], v[98:99] op_sel:[0,1,0] op_sel_hi:[1,1,1]
  v_pk_fma_f32 v[106:107], v[18:19], v[46:47], v[106:107] op_sel_hi:[1,0,1]
  v_pk_fma_f32 v[114:115], v[18:19], v[46:47], v[114:115] op_sel:[0,1,0] op_sel_hi:[1,1,1]
  s_waitcnt vmcnt(9) lgkmcnt(8)
  v_lshlrev_b32 v16, 16, v120
  v_and_b32 v17, s15, v120
  v_pk_fma_f32 v[84:85], v[16:17], v[48:49], v[84:85] op_sel_hi:[1,0,1]
  v_pk_fma_f32 v[92:93], v[16:17], v[48:49], v[92:93] op_sel:[0,1,0] op_sel_hi:[1,1,1]
  v_pk_fma_f32 v[100:101], v[16:17], v[50:51], v[100:101] op_sel_hi:[1,0,1]
  v_pk_fma_f32 v[108:109], v[16:17], v[50:51], v[108:109] op_sel:[0,1,0] op_sel_hi:[1,1,1]
  v_lshlrev_b32 v18, 16, v121
  v_and_b32 v19, s15, v121
  v_pk_fma_f32 v[86:87], v[18:19], v[48:49], v[86:87] op_sel_hi:[1,0,1]
  v_pk_fma_f32 v[94:95], v[18:19], v[48:49], v[94:95] op_sel:[0,1,0] op_sel_hi:[1,1,1]
  v_pk_fma_f32 v[102:103], v[18:19], v[50:51], v[102:103] op_sel_hi:[1,0,1]
  v_pk_fma_f32 v[110:111], v[18:19], v[50:51], v[110:111] op_sel:[0,1,0] op_sel_hi:[1,1,1]
  v_lshlrev_b32 v16, 16, v122
  v_and_b32 v17, s15, v122
  v_pk_fma_f32 v[88:89], v[16:17], v[48:49], v[88:89] op_sel_hi:[1,0,1]
  v_pk_fma_f32 v[96:97], v[16:17], v[48:49], v[96:97] op_sel:[0,1,0] op_sel_hi:[1,1,1]
  v_pk_fma_f32 v[104:105], v[16:17], v[50:51], v[104:105] op_sel_hi:[1,0,1]
  v_pk_fma_f32 v[112:113], v[16:17], v[50:51], v[112:113] op_sel:[0,1,0] op_sel_hi:[1,1,1]
  v_lshlrev_b32 v18, 16, v123
  v_and_b32 v19, s15, v123
  v_pk_fma_f32 v[90:91], v[18:19], v[48:49], v[90:91] op_sel_hi:[1,0,1]
  v_pk_fma_f32 v[98:99], v[18:19], v[48:49], v[98:99] op_sel:[0,1,0] op_sel_hi:[1,1,1]
  v_pk_fma_f32 v[106:107], v[18:19], v[50:51], v[106:107] op_sel_hi:[1,0,1]
  v_pk_fma_f32 v[114:115], v[18:19], v[50:51], v[114:115] op_sel:[0,1,0] op_sel_hi:[1,1,1]
  s_waitcnt vmcnt(8) lgkmcnt(7)
  v_lshlrev_b32 v16, 16, v124
  v_and_b32 v17, s15, v124
  v_pk_fma_f32 v[84:85], v[16:17], v[52:53], v[84:85] op_sel_hi:[1,0,1]
  v_pk_fma_f32 v[92:93], v[16:17], v[52:53], v[92:93] op_sel:[0,1,0] op_sel_hi:[1,1,1]
  v_pk_fma_f32 v[100:101], v[16:17], v[54:55], v[100:101] op_sel_hi:[1,0,1]
  v_pk_fma_f32 v[108:109], v[16:17], v[54:55], v[108:109] op_sel:[0,1,0] op_sel_hi:[1,1,1]
  v_lshlrev_b32 v18, 16, v125
  v_and_b32 v19, s15, v125
  v_pk_fma_f32 v[86:87], v[18:19], v[52:53], v[86:87] op_sel_hi:[1,0,1]
  v_pk_fma_f32 v[94:95], v[18:19], v[52:53], v[94:95] op_sel:[0,1,0] op_sel_hi:[1,1,1]
  v_pk_fma_f32 v[102:103], v[18:19], v[54:55], v[102:103] op_sel_hi:[1,0,1]
  v_pk_fma_f32 v[110:111], v[18:19], v[54:55], v[110:111] op_sel:[0,1,0] op_sel_hi:[1,1,1]
  v_lshlrev_b32 v16, 16, v126
  v_and_b32 v17, s15, v126
  v_pk_fma_f32 v[88:89], v[16:17], v[52:53], v[88:89] op_sel_hi:[1,0,1]
  v_pk_fma_f32 v[96:97], v[16:17], v[52:53], v[96:97] op_sel:[0,1,0] op_sel_hi:[1,1,1]
  v_pk_fma_f32 v[104:105], v[16:17], v[54:55], v[104:105] op_sel_hi:[1,0,1]
  v_pk_fma_f32 v[112:113], v[16:17], v[54:55], v[112:113] op_sel:[0,1,0] op_sel_hi:[1,1,1]
  v_lshlrev_b32 v18, 16, v127
  v_and_b32 v19, s15, v127
  v_pk_fma_f32 v[90:91], v[18:19], v[52:53], v[90:91] op_sel_hi:[1,0,1]
  v_pk_fma_f32 v[98:99], v[18:19], v[52:53], v[98:99] op_sel:[0,1,0] op_sel_hi:[1,1,1]
  v_pk_fma_f32 v[106:107], v[18:19], v[54:55], v[106:107] op_sel_hi:[1,0,1]
  v_pk_fma_f32 v[114:115], v[18:19], v[54:55], v[114:115] op_sel:[0,1,0] op_sel_hi:[1,1,1]
  s_waitcnt vmcnt(7) lgkmcnt(6)
  v_lshlrev_b32 v16, 16, v128
  v_and_b32 v17, s15, v128
  v_pk_fma_f32 v[84:85], v[16:17], v[56:57], v[84:85] op_sel_hi:[1,0,1]
  v_pk_fma_f32 v[92:93], v[16:17], v[56:57], v[92:93] op_sel:[0,1,0] op_sel_hi:[1,1,1]
  v_pk_fma_f32 v[100:101], v[16:17], v[58:59], v[100:101] op_sel_hi:[1,0,1]
  v_pk_fma_f32 v[108:109], v[16:17], v[58:59], v[108:109] op_sel:[0,1,0] op_sel_hi:[1,1,1]
  v_lshlrev_b32 v18, 16, v129
  v_and_b32 v19, s15, v129
  v_pk_fma_f32 v[86:87], v[18:19], v[56:57], v[86:87] op_sel_hi:[1,0,1]
  v_pk_fma_f32 v[94:95], v[18:19], v[56:57], v[94:95] op_sel:[0,1,0] op_sel_hi:[1,1,1]
  v_pk_fma_f32 v[102:103], v[18:19], v[58:59], v[102:103] op_sel_hi:[1,0,1]
  v_pk_fma_f32 v[110:111], v[18:19], v[58:59], v[110:111] op_sel:[0,1,0] op_sel_hi:[1,1,1]
  v_lshlrev_b32 v16, 16, v130
  v_and_b32 v17, s15, v130
  v_pk_fma_f32 v[88:89], v[16:17], v[56:57], v[88:89] op_sel_hi:[1,0,1]
  v_pk_fma_f32 v[96:97], v[16:17], v[56:57], v[96:97] op_sel:[0,1,0] op_sel_hi:[1,1,1]
  v_pk_fma_f32 v[104:105], v[16:17], v[58:59], v[104:105] op_sel_hi:[1,0,1]
  v_pk_fma_f32 v[112:113], v[16:17], v[58:59], v[112:113] op_sel:[0,1,0] op_sel_hi:[1,1,1]
  v_lshlrev_b32 v18, 16, v131
  v_and_b32 v19, s15, v131
  v_pk_fma_f32 v[90:91], v[18:19], v[56:57], v[90:91] op_sel_hi:[1,0,1]
  v_pk_fma_f32 v[98:99], v[18:19], v[56:57], v[98:99] op_sel:[0,1,0] op_sel_hi:[1,1,1]
  v_pk_fma_f32 v[106:107], v[18:19], v[58:59], v[106:107] op_sel_hi:[1,0,1]
  v_pk_fma_f32 v[114:115], v[18:19], v[58:59], v[114:115] op_sel:[0,1,0] op_sel_hi:[1,1,1]
  s_waitcnt vmcnt(6) lgkmcnt(5)
  v_lshlrev_b32 v16, 16, v132
  v_and_b32 v17, s15, v132
  v_pk_fma_f32 v[84:85], v[16:17], v[60:61], v[84:85] op_sel_hi:[1,0,1]
  v_pk_fma_f32 v[92:93], v[16:17], v[60:61], v[92:93] op_sel:[0,1,0] op_sel_hi:[1,1,1]
  v_pk_fma_f32 v[100:101], v[16:17], v[62:63], v[100:101] op_sel_hi:[1,0,1]
  v_pk_fma_f32 v[108:109], v[16:17], v[62:63], v[108:109] op_sel:[0,1,0] op_sel_hi:[1,1,1]
  v_lshlrev_b32 v18, 16, v133
  v_and_b32 v19, s15, v133
  v_pk_fma_f32 v[86:87], v[18:19], v[60:61], v[86:87] op_sel_hi:[1,0,1]
  v_pk_fma_f32 v[94:95], v[18:19], v[60:61], v[94:95] op_sel:[0,1,0] op_sel_hi:[1,1,1]
  v_pk_fma_f32 v[102:103], v[18:19], v[62:63], v[102:103] op_sel_hi:[1,0,1]
  v_pk_fma_f32 v[110:111], v[18:19], v[62:63], v[110:111] op_sel:[0,1,0] op_sel_hi:[1,1,1]
  v_lshlrev_b32 v16, 16, v134
  v_and_b32 v17, s15, v134
  v_pk_fma_f32 v[88:89], v[16:17], v[60:61], v[88:89] op_sel_hi:[1,0,1]
  v_pk_fma_f32 v[96:97], v[16:17], v[60:61], v[96:97] op_sel:[0,1,0] op_sel_hi:[1,1,1]
  v_pk_fma_f32 v[104:105], v[16:17], v[62:63], v[104:105] op_sel_hi:[1,0,1]
  v_pk_fma_f32 v[112:113], v[16:17], v[62:63], v[112:113] op_sel:[0,1,0] op_sel_hi:[1,1,1]
  v_lshlrev_b32 v18, 16, v135
  v_and_b32 v19, s15, v135
  v_pk_fma_f32 v[90:91], v[18:19], v[60:61], v[90:91] op_sel_hi:[1,0,1]
  v_pk_fma_f32 v[98:99], v[18:19], v[60:61], v[98:99] op_sel:[0,1,0] op_sel_hi:[1,1,1]
  v_pk_fma_f32 v[106:107], v[18:19], v[62:63], v[106:107] op_sel_hi:[1,0,1]
  v_pk_fma_f32 v[114:115], v[18:19], v[62:63], v[114:115] op_sel:[0,1,0] op_sel_hi:[1,1,1]
  s_waitcnt vmcnt(5) lgkmcnt(4)
  v_lshlrev_b32 v16, 16, v136
  v_and_b32 v17, s15, v136
  v_pk_fma_f32 v[84:85], v[16:17], v[64:65], v[84:85] op_sel_hi:[1,0,1]
  v_pk_fma_f32 v[92:93], v[16:17], v[64:65], v[92:93] op_sel:[0,1,0] op_sel_hi:[1,1,1]
  v_pk_fma_f32 v[100:101], v[16:17], v[66:67], v[100:101] op_sel_hi:[1,0,1]
  v_pk_fma_f32 v[108:109], v[16:17], v[66:67], v[108:109] op_sel:[0,1,0] op_sel_hi:[1,1,1]
  v_lshlrev_b32 v18, 16, v137
  v_and_b32 v19, s15, v137
  v_pk_fma_f32 v[86:87], v[18:19], v[64:65], v[86:87] op_sel_hi:[1,0,1]
  v_pk_fma_f32 v[94:95], v[18:19], v[64:65], v[94:95] op_sel:[0,1,0] op_sel_hi:[1,1,1]
  v_pk_fma_f32 v[102:103], v[18:19], v[66:67], v[102:103] op_sel_hi:[1,0,1]
  v_pk_fma_f32 v[110:111], v[18:19], v[66:67], v[110:111] op_sel:[0,1,0] op_sel_hi:[1,1,1]
  v_lshlrev_b32 v16, 16, v138
  v_and_b32 v17, s15, v138
  v_pk_fma_f32 v[88:89], v[16:17], v[64:65], v[88:89] op_sel_hi:[1,0,1]
  v_pk_fma_f32 v[96:97], v[16:17], v[64:65], v[96:97] op_sel:[0,1,0] op_sel_hi:[1,1,1]
  v_pk_fma_f32 v[104:105], v[16:17], v[66:67], v[104:105] op_sel_hi:[1,0,1]
  v_pk_fma_f32 v[112:113], v[16:17], v[66:67], v[112:113] op_sel:[0,1,0] op_sel_hi:[1,1,1]
  v_lshlrev_b32 v18, 16, v139
  v_and_b32 v19, s15, v139
  v_pk_fma_f32 v[90:91], v[18:19], v[64:65], v[90:91] op_sel_hi:[1,0,1]
  v_pk_fma_f32 v[98:99], v[18:19], v[64:65], v[98:99] op_sel:[0,1,0] op_sel_hi:[1,1,1]
  v_pk_fma_f32 v[106:107], v[18:19], v[66:67], v[106:107] op_sel_hi:[1,0,1]
  v_pk_fma_f32 v[114:115], v[18:19], v[66:67], v[114:115] op_sel:[0,1,0] op_sel_hi:[1,1,1]
  s_waitcnt vmcnt(4) lgkmcnt(3)
  v_lshlrev_b32 v16, 16, v140
  v_and_b32 v17, s15, v140
  v_pk_fma_f32 v[84:85], v[16:17], v[68:69], v[84:85] op_sel_hi:[1,0,1]
  v_pk_fma_f32 v[92:93], v[16:17], v[68:69], v[92:93] op_sel:[0,1,0] op_sel_hi:[1,1,1]
  v_pk_fma_f32 v[100:101], v[16:17], v[70:71], v[100:101] op_sel_hi:[1,0,1]
  v_pk_fma_f32 v[108:109], v[16:17], v[70:71], v[108:109] op_sel:[0,1,0] op_sel_hi:[1,1,1]
  v_lshlrev_b32 v18, 16, v141
  v_and_b32 v19, s15, v141
  v_pk_fma_f32 v[86:87], v[18:19], v[68:69], v[86:87] op_sel_hi:[1,0,1]
  v_pk_fma_f32 v[94:95], v[18:19], v[68:69], v[94:95] op_sel:[0,1,0] op_sel_hi:[1,1,1]
  v_pk_fma_f32 v[102:103], v[18:19], v[70:71], v[102:103] op_sel_hi:[1,0,1]
  v_pk_fma_f32 v[110:111], v[18:19], v[70:71], v[110:111] op_sel:[0,1,0] op_sel_hi:[1,1,1]
  v_lshlrev_b32 v16, 16, v142
  v_and_b32 v17, s15, v142
  v_pk_fma_f32 v[88:89], v[16:17], v[68:69], v[88:89] op_sel_hi:[1,0,1]
  v_pk_fma_f32 v[96:97], v[16:17], v[68:69], v[96:97] op_sel:[0,1,0] op_sel_hi:[1,1,1]
  v_pk_fma_f32 v[104:105], v[16:17], v[70:71], v[104:105] op_sel_hi:[1,0,1]
  v_pk_fma_f32 v[112:113], v[16:17], v[70:71], v[112:113] op_sel:[0,1,0] op_sel_hi:[1,1,1]
  v_lshlrev_b32 v18, 16, v143
  v_and_b32 v19, s15, v143
  v_pk_fma_f32 v[90:91], v[18:19], v[68:69], v[90:91] op_sel_hi:[1,0,1]
  v_pk_fma_f32 v[98:99], v[18:19], v[68:69], v[98:99] op_sel:[0,1,0] op_sel_hi:[1,1,1]
  v_pk_fma_f32 v[106:107], v[18:19], v[70:71], v[106:107] op_sel_hi:[1,0,1]
  v_pk_fma_f32 v[114:115], v[18:19], v[70:71], v[114:115] op_sel:[0,1,0] op_sel_hi:[1,1,1]
  s_waitcnt vmcnt(3) lgkmcnt(2)
  v_lshlrev_b32 v16, 16, v144
  v_and_b32 v17, s15, v144
  v_pk_fma_f32 v[84:85], v[16:17], v[72:73], v[84:85] op_sel_hi:[1,0,1]
  v_pk_fma_f32 v[92:93], v[16:17], v[72:73], v[92:93] op_sel:[0,1,0] op_sel_hi:[1,1,1]
  v_pk_fma_f32 v[100:101], v[16:17], v[74:75], v[100:101] op_sel_hi:[1,0,1]
  v_pk_fma_f32 v[108:109], v[16:17], v[74:75], v[108:109] op_sel:[0,1,0] op_sel_hi:[1,1,1]
  v_lshlrev_b32 v18, 16, v145
  v_and_b32 v19, s15, v145
  v_pk_fma_f32 v[86:87], v[18:19], v[72:73], v[86:87] op_sel_hi:[1,0,1]
  v_pk_fma_f32 v[94:95], v[18:19], v[72:73], v[94:95] op_sel:[0,1,0] op_sel_hi:[1,1,1]
  v_pk_fma_f32 v[102:103], v[18:19], v[74:75], v[102:103] op_sel_hi:[1,0,1]
  v_pk_fma_f32 v[110:111], v[18:19], v[74:75], v[110:111] op_sel:[0,1,0] op_sel_hi:[1,1,1]
  v_lshlrev_b32 v16, 16, v146
  v_and_b32 v17, s15, v146
  v_pk_fma_f32 v[88:89], v[16:17], v[72:73], v[88:89] op_sel_hi:[1,0,1]
  v_pk_fma_f32 v[96:97], v[16:17], v[72:73], v[96:97] op_sel:[0,1,0] op_sel_hi:[1,1,1]
  v_pk_fma_f32 v[104:105], v[16:17], v[74:75], v[104:105] op_sel_hi:[1,0,1]
  v_pk_fma_f32 v[112:113], v[16:17], v[74:75], v[112:113] op_sel:[0,1,0] op_sel_hi:[1,1,1]
  v_lshlrev_b32 v18, 16, v147
  v_and_b32 v19, s15, v147
  v_pk_fma_f32 v[90:91], v[18:19], v[72:73], v[90:91] op_sel_hi:[1,0,1]
  v_pk_fma_f32 v[98:99], v[18:19], v[72:73], v[98:99] op_sel:[0,1,0] op_sel_hi:[1,1,1]
  v_pk_fma_f32 v[106:107], v[18:19], v[74:75], v[106:107] op_sel_hi:[1,0,1]
  v_pk_fma_f32 v[114:115], v[18:19], v[74:75], v[114:115] op_sel:[0,1,0] op_sel_hi:[1,1,1]
  s_waitcnt vmcnt(2) lgkmcnt(1)
  v_lshlrev_b32 v16, 16, v148
  v_and_b32 v17, s15, v148
  v_pk_fma_f32 v[84:85], v[16:17], v[76:77], v[84:85] op_sel_hi:[1,0,1]
  v_pk_fma_f32 v[92:93], v[16:17], v[76:77], v[92:93] op_sel:[0,1,0] op_sel_hi:[1,1,1]
  v_pk_fma_f32 v[100:101], v[16:17], v[78:79], v[100:101] op_sel_hi:[1,0,1]
  v_pk_fma_f32 v[108:109], v[16:17], v[78:79], v[108:109] op_sel:[0,1,0] op_sel_hi:[1,1,1]
  v_lshlrev_b32 v18, 16, v149
  v_and_b32 v19, s15, v149
  v_pk_fma_f32 v[86:87], v[18:19], v[76:77], v[86:87] op_sel_hi:[1,0,1]
  v_pk_fma_f32 v[94:95], v[18:19], v[76:77], v[94:95] op_sel:[0,1,0] op_sel_hi:[1,1,1]
  v_pk_fma_f32 v[102:103], v[18:19], v[78:79], v[102:103] op_sel_hi:[1,0,1]
  v_pk_fma_f32 v[110:111], v[18:19], v[78:79], v[110:111] op_sel:[0,1,0] op_sel_hi:[1,1,1]
  v_lshlrev_b32 v16, 16, v150
  v_and_b32 v17, s15, v150
  v_pk_fma_f32 v[88:89], v[16:17], v[76:77], v[88:89] op_sel_hi:[1,0,1]
  v_pk_fma_f32 v[96:97], v[16:17], v[76:77], v[96:97] op_sel:[0,1,0] op_sel_hi:[1,1,1]
  v_pk_fma_f32 v[104:105], v[16:17], v[78:79], v[104:105] op_sel_hi:[1,0,1]
  v_pk_fma_f32 v[112:113], v[16:17], v[78:79], v[112:113] op_sel:[0,1,0] op_sel_hi:[1,1,1]
  v_lshlrev_b32 v18, 16, v151
  v_and_b32 v19, s15, v151
  v_pk_fma_f32 v[90:91], v[18:19], v[76:77], v[90:91] op_sel_hi:[1,0,1]
  v_pk_fma_f32 v[98:99], v[18:19], v[76:77], v[98:99] op_sel:[0,1,0] op_sel_hi:[1,1,1]
  v_pk_fma_f32 v[106:107], v[18:19], v[78:79], v[106:107] op_sel_hi:[1,0,1]
  v_pk_fma_f32 v[114:115], v[18:19], v[78:79], v[114:115] op_sel:[0,1,0] op_sel_hi:[1,1,1]
  s_waitcnt vmcnt(0) lgkmcnt(0)
  v_lshlrev_b32 v16, 16, v152
  v_and_b32 v17, s15, v152
  v_pk_fma_f32 v[84:85], v[16:17], v[80:81], v[84:85] op_sel_hi:[1,0,1]
  v_pk_fma_f32 v[92:93], v[16:17], v[80:81], v[92:93] op_sel:[0,1,0] op_sel_hi:[1,1,1]
  v_pk_fma_f32 v[100:101], v[16:17], v[82:83], v[100:101] op_sel_hi:[1,0,1]
  v_pk_fma_f32 v[108:109], v[16:17], v[82:83], v[108:109] op_sel:[0,1,0] op_sel_hi:[1,1,1]
  v_lshlrev_b32 v18, 16, v153
  v_and_b32 v19, s15, v153
  v_pk_fma_f32 v[86:87], v[18:19], v[80:81], v[86:87] op_sel_hi:[1,0,1]
  v_pk_fma_f32 v[94:95], v[18:19], v[80:81], v[94:95] op_sel:[0,1,0] op_sel_hi:[1,1,1]
  v_pk_fma_f32 v[102:103], v[18:19], v[82:83], v[102:103] op_sel_hi:[1,0,1]
  v_pk_fma_f32 v[110:111], v[18:19], v[82:83], v[110:111] op_sel:[0,1,0] op_sel_hi:[1,1,1]
  v_lshlrev_b32 v16, 16, v154
  v_and_b32 v17, s15, v154
  v_pk_fma_f32 v[88:89], v[16:17], v[80:81], v[88:89] op_sel_hi:[1,0,1]
  v_pk_fma_f32 v[96:97], v[16:17], v[80:81], v[96:97] op_sel:[0,1,0] op_sel_hi:[1,1,1]
  v_pk_fma_f32 v[104:105], v[16:17], v[82:83], v[104:105] op_sel_hi:[1,0,1]
  v_pk_fma_f32 v[112:113], v[16:17], v[82:83], v[112:113] op_sel:[0,1,0] op_sel_hi:[1,1,1]
  v_lshlrev_b32 v18, 16, v155
  v_and_b32 v19, s15, v155
  v_pk_fma_f32 v[90:91], v[18:19], v[80:81], v[90:91] op_sel_hi:[1,0,1]
  v_pk_fma_f32 v[98:99], v[18:19], v[80:81], v[98:99] op_sel:[0,1,0] op_sel_hi:[1,1,1]
  v_pk_fma_f32 v[106:107], v[18:19], v[82:83], v[106:107] op_sel_hi:[1,0,1]
  v_pk_fma_f32 v[114:115], v[18:19], v[82:83], v[114:115] op_sel:[0,1,0] op_sel_hi:[1,1,1]
  s_nop 1
  v_permlane32_swap_b32 v84, v100
  v_permlane32_swap_b32 v85, v101
  v_permlane32_swap_b32 v86, v102
  v_permlane32_swap_b32 v87, v103
  v_permlane32_swap_b32 v88, v104
  v_permlane32_swap_b32 v89, v105
  v_permlane32_swap_b32 v90, v106
  v_permlane32_swap_b32 v91, v107
  v_permlane32_swap_b32 v92, v108
  v_permlane32_swap_b32 v93, v109
  v_permlane32_swap_b32 v94, v110
  v_permlane32_swap_b32 v95, v111
  v_permlane32_swap_b32 v96, v112
  v_permlane32_swap_b32 v97, v113
  v_permlane32_swap_b32 v98, v114
  v_permlane32_swap_b32 v99, v115
  v_add_f32 v84, v84, v100
  v_add_f32 v85, v85, v101
  v_add_f32 v86, v86, v102
  v_add_f32 v87, v87, v103
  v_add_f32 v88, v88, v104
  v_add_f32 v89, v89, v105
  v_add_f32 v90, v90, v106
  v_add_f32 v91, v91, v107
  v_add_f32 v92, v92, v108
  v_add_f32 v93, v93, v109
  v_add_f32 v94, v94, v110
  v_add_f32 v95, v95, v111
  v_add_f32 v96, v96, v112
  v_add_f32 v97, v97, v113
  v_add_f32 v98, v98, v114
  v_add_f32 v99, v99, v115
  s_nop 1
  v_permlane16_swap_b32 v84, v92
  v_permlane16_swap_b32 v85, v93
  v_permlane16_swap_b32 v86, v94
  v_permlane16_swap_b32 v87, v95
  v_permlane16_swap_b32 v88, v96
  v_permlane16_swap_b32 v89, v97
  v_permlane16_swap_b32 v90, v98
  v_permlane16_swap_b32 v91, v99
  v_add_f32 v84, v84, v92
  v_add_f32 v85, v85, v93
  v_add_f32 v86, v86, v94
  v_add_f32 v87, v87, v95
  v_add_f32 v88, v88, v96
  v_add_f32 v89, v89, v97
  v_add_f32 v90, v90, v98
  v_add_f32 v91, v91, v99
  s_nop 1
  v_add_f32_dpp v156, v84, v84 row_ror:8 row_mask:0xf bank_mask:0x3
  v_add_f32_dpp v156, v88, v88 row_ror:8 row_mask:0xf bank_mask:0xc
  v_add_f32_dpp v157, v85, v85 row_ror:8 row_mask:0xf bank_mask:0x3
  v_add_f32_dpp v157, v89, v89 row_ror:8 row_mask:0xf bank_mask:0xc
  v_add_f32_dpp v158, v86, v86 row_ror:8 row_mask:0xf bank_mask:0x3
  v_add_f32_dpp v158, v90, v90 row_ror:8 row_mask:0xf bank_mask:0xc
  v_add_f32_dpp v159, v87, v87 row_ror:8 row_mask:0xf bank_mask:0x3
  v_add_f32_dpp v159, v91, v91 row_ror:8 row_mask:0xf bank_mask:0xc
  global_store_dwordx4 v5, v[156:159], s[40:41] sc1
  v_bitop3_b32 v160, v156, v157, v158 bitop3:0x96
  v_bitop3_b32 v160, v160, v159, s78 bitop3:0x96
  global_store_dword v6, v160, s[40:41] sc1
  s_lshl_b32 s8, s4, 2
  s_add_u32 s8, s8, s3
  s_lshl_b32 s8, s8, 10
  s_add_u32 s8, s8, 131072
  v_lshl_add_u32 v14, v1, 4, s8
  s_lshl_b32 s9, s3, 9
  v_lshl_add_u32 v15, v1, 3, s9
  s_mov_b32 s79, 524288
  s_lshl_b32 s8, s3, 2
  s_add_u32 s8, s8, 2080
  v_mov_b32 v156, s8
  s_lshl_b32 s13, s3, 1
  s_cmp_eq_u32 s13, s5
  s_cselect_b32 s13, 1, 0
  s_cmp_lt_u32 s3, 1
  s_cselect_b32 s13, 2, s13
  s_cmp_eq_u32 s13, 0
  s_cbranch_scc1 L_nonhome
  s_lshl_b32 s9, s3, 10
  s_add_u32 s8, s95, s9
  v_lshl_add_u32 v5, v1, 4, s8
  s_lshl_b32 s10, s3, 6
  s_add_u32 s9, s95, s10
  s_add_u32 s9, s9, 32768
  v_lshrrev_b32 v3, 4, v1
  v_lshl_add_u32 v6, v3, 8, s9
  v_and_b32 v3, 1, v1
  v_lshl_add_u32 v6, v3, 5, v6
  v_bfe_u32 v3, v1, 1, 3
  v_lshl_add_u32 v6, v3, 2, v6
  v_add_u32 v4, 4096, v6
  s_barrier
  s_mov_b32 s11, 1
L_qpoll:
  v_mov_b32 v3, v5
  global_load_dwordx4 v[164:167], v3, s[40:41] sc1
  global_load_dword v196, v6, s[40:41] offset:0 sc1
  v_add_u32 v3, 4096, v3
  global_load_dwordx4 v[168:171], v3, s[40:41] sc1
  global_load_dword v197, v6, s[40:41] offset:1024 sc1
  v_add_u32 v3, 4096, v3
  global_load_dwordx4 v[172:175], v3, s[40:41] sc1
  global_load_dword v198, v6, s[40:41] offset:2048 sc1
  v_add_u32 v3, 4096, v3
  global_load_dwordx4 v[176:179], v3, s[40:41] sc1
  global_load_dword v199, v6, s[40:41] offset:3072 sc1
  v_add_u32 v3, 4096, v3
  global_load_dwordx4 v[180:183], v3, s[40:41] sc1
  global_load_dword v200, v4, s[40:41] offset:0 sc1
  v_add_u32 v3, 4096, v3
  global_load_dwordx4 v[184:187], v3, s[40:41] sc1
  global_load_dword v201, v4, s[40:41] offset:1024 sc1
  v_add_u32 v3, 4096, v3
  global_load_dwordx4 v[188:191], v3, s[40:41] sc1
  global_load_dword v202, v4, s[40:41] offset:2048 sc1
  v_add_u32 v3, 4096, v3
  global_load_dwordx4 v[192:195], v3, s[40:41] sc1
  global_load_dword v203, v4, s[40:41] offset:3072 sc1
  s_cmp_eq_u32 s11, 0
  s_cbranch_scc1 L_noyb
  s_barrier
  s_mov_b32 s11, 0
L_noyb:
  s_waitcnt vmcnt(14)
  v_bitop3_b32 v8, v164, v165, v166 bitop3:0x96
  v_bitop3_b32 v9, v167, v196, s78 bitop3:0x96
  v_xor_b32 v10, v8, v9
  s_waitcnt vmcnt(12)
  v_bitop3_b32 v8, v168, v169, v170 bitop3:0x96
  v_bitop3_b32 v9, v171, v197, s78 bitop3:0x96
  v_xor_b32 v8, v8, v9
  v_or_b32 v10, v10, v8
  s_waitcnt vmcnt(10)
  v_bitop3_b32 v8, v172, v173, v174 bitop3:0x96
  v_bitop3_b32 v9, v175, v198, s78 bitop3:0x96
  v_xor_b32 v8, v8, v9
  v_or_b32 v10, v10, v8
  s_waitcnt vmcnt(8)
  v_bitop3_b32 v8, v176, v177, v178 bitop3:0x96
  v_bitop3_b32 v9, v179, v199, s78 bitop3:0x96
  v_xor_b32 v8, v8, v9
  v_or_b32 v10, v10, v8
  s_waitcnt vmcnt(6)
  v_bitop3_b32 v8, v180, v181, v182 bitop3:0x96
  v_bitop3_b32 v9, v183, v200, s78 bitop3:0x96
  v_xor_b32 v8, v8, v9
  v_or_b32 v10, v10, v8
  s_waitcnt vmcnt(4)
  v_bitop3_b32 v8, v184, v185, v186 bitop3:0x96
  v_bitop3_b32 v9, v187, v201, s78 bitop3:0x96
  v_xor_b32 v8, v8, v9
  v_or_b32 v10, v10, v8
  s_waitcnt vmcnt(2)
  v_bitop3_b32 v8, v188, v189, v190 bitop3:0x96
  v_bitop3_b32 v9, v191, v202, s78 bitop3:0x96
  v_xor_b32 v8, v8, v9
  v_or_b32 v10, v10, v8
  s_waitcnt vmcnt(0)
  v_bitop3_b32 v8, v192, v193, v194 bitop3:0x96
  v_bitop3_b32 v9, v195, v203, s78 bitop3:0x96
  v_xor_b32 v8, v8, v9
  v_or_b32 v10, v10, v8
  v_cmp_ne_u32 vcc, 0, v10
  s_cbranch_vccz L_qok
  s_sub_u32 s79, s79, 1
  s_cmp_lg_u32 s79, 0
  s_cbranch_scc1 L_qpoll
L_qok:
  v_pk_add_f32 v[164:165], v[164:165], v[168:169]
  v_pk_add_f32 v[166:167], v[166:167], v[170:171]
  v_pk_add_f32 v[164:165], v[164:165], v[172:173]
  v_pk_add_f32 v[166:167], v[166:167], v[174:175]
  v_pk_add_f32 v[164:165], v[164:165], v[176:177]
  v_pk_add_f32 v[166:167], v[166:167], v[178:179]
  v_pk_add_f32 v[164:165], v[164:165], v[180:181]
  v_pk_add_f32 v[166:167], v[166:167], v[182:183]
  v_pk_add_f32 v[164:165], v[164:165], v[184:185]
  v_pk_add_f32 v[166:167], v[166:167], v[186:187]
  v_pk_add_f32 v[164:165], v[164:165], v[188:189]
  v_pk_add_f32 v[166:167], v[166:167], v[190:191]
  v_pk_add_f32 v[164:165], v[164:165], v[192:193]
  v_pk_add_f32 v[166:167], v[166:167], v[194:195]
  v_cvt_pk_bf16_f32 v168, v164, v165
  v_cvt_pk_bf16_f32 v169, v166, v167
  ds_write_b64 v15, v[168:169] offset:0
  ds_write_b32 v156, v7
  s_setprio 0
  v_lshlrev_b32 v172, 16, v168
  v_and_b32 v173, s15, v168
  v_lshlrev_b32 v174, 16, v169
  v_and_b32 v175, s15, v169
  v_lshlrev_b32 v176, 16, v204
  v_and_b32 v177, s15, v204
  v_lshlrev_b32 v178, 16, v205
  v_and_b32 v179, s15, v205
  v_add_f32 v172, v172, v176
  v_add_f32 v173, v173, v177
  v_add_f32 v174, v174, v178
  v_add_f32 v175, v175, v179
  v_cvt_pk_bf16_f32 v8, v172, v173
  v_lshlrev_b32 v172, 16, v8
  v_and_b32 v173, s15, v8
  v_cvt_pk_bf16_f32 v8, v174, v175
  v_lshlrev_b32 v174, 16, v8
  v_and_b32 v175, s15, v8
  v_cmp_gt_f32 vcc, v172, 0
  s_nop 1
  v_cndmask_b32 v172, 0, v172, vcc
  v_cmp_gt_f32 vcc, v173, 0
  s_nop 1
  v_cndmask_b32 v173, 0, v173, vcc
  v_cmp_gt_f32 vcc, v174, 0
  s_nop 1
  v_cndmask_b32 v174, 0, v174, vcc
  v_cmp_gt_f32 vcc, v175, 0
  s_nop 1
  v_cndmask_b32 v175, 0, v175, vcc
  v_mul_f32 v172, v172, v172
  v_mul_f32 v173, v173, v173
  v_mul_f32 v174, v174, v174
  v_mul_f32 v175, v175, v175
  s_mov_b32 exec_lo, 0x0
  s_mov_b32 exec_hi, 0xffff0000
  v_cvt_pk_bf16_f32 v168, v172, v173
  v_cvt_pk_bf16_f32 v169, v174, v175
  ds_write_b64 v15, v[168:169] offset:0
  s_mov_b64 exec, -1
  v_bitop3_b32 v170, v168, v169, s78 bitop3:0x96
  s_cmp_eq_u32 s13, 1
  s_cbranch_scc0 L_rowdone
  global_store_dwordx4 v14, v[168:171], s[40:41] sc1
  s_branch L_rowdone
L_nonhome:
  s_barrier
  s_barrier
  s_waitcnt lgkmcnt(0)
  s_setprio 0
  v_mov_b32 v4, 2048
  s_mov_b32 s79, 8388608
L_fw:
  ds_read_b32 v3, v4 offset:28
  s_waitcnt lgkmcnt(0)
  v_readfirstlane_b32 s8, v3
  s_sub_u32 s79, s79, 1
  s_cselect_b32 s8, 4, s8
  s_cmp_ge_u32 s8, 4
  s_cbranch_scc1 L_fwok
  s_sleep 8
  s_branch L_fw
L_fwok:
  s_mov_b32 s79, 524288
L_fpoll:
  global_load_dwordx4 v[168:171], v14, s[40:41] sc1
  s_waitcnt vmcnt(0)
  v_bitop3_b32 v8, v168, v169, v170 bitop3:0x96
  v_cmp_ne_u32 vcc, s78, v8
  s_cbranch_vccz L_fok
  s_sleep 32
  s_sub_u32 s79, s79, 1
  s_cmp_lg_u32 s79, 0
  s_cbranch_scc1 L_fpoll
L_fok:
  ds_write_b64 v15, v[168:169] offset:0
  ds_write_b32 v156, v7
L_rowdone:
  v_mov_b32 v4, 2048
  s_waitcnt lgkmcnt(0)
  s_mov_b64 exec, 1
  ds_add_u32 v4, v7
  s_mov_b64 exec, -1
  v_lshrrev_b32 v3, 3, v1
  v_mul_u32_u24 v2, 1152, v3
  v_lshl_add_u32 v2, v1, 4, v2
  s_mov_b32 s80, s24
  s_mov_b32 s81, s25
  s_mov_b32 s82, 7864320
  s_mov_b32 s83, 0x20000
  s_mov_b32 s44, s32
  s_mov_b32 s45, s33
  s_mov_b32 s46, 1966080
  s_mov_b32 s47, 0x20000
  s_lshl_b32 s8, s4, 2
  s_add_u32 s8, s8, s3
  s_lshl_b32 s10, s5, 7
  s_mul_i32 s84, s8, 61440
  s_add_u32 s84, s84, s10
  s_mul_i32 s62, s8, 20480
  s_add_u32 s62, s62, s10
  s_lshl_b32 s9, s8, 10
  s_add_u32 s9, s9, 917504
  v_and_b32 v3, 7, v1
  v_lshl_add_u32 v36, v3, 7, s9
  s_lshl_b32 s9, s8, 13
  s_add_u32 s9, s9, 1048576
  v_lshl_add_u32 v37, v1, 4, s9
  v_add_u32 v38, 4096, v37
  s_mul_i32 s9, s3, 384
  v_lshl_add_u32 v39, v1, 1, s9
  s_mul_i32 s8, s3, 6144
  s_add_u32 s8, s8, 32768
  v_lshl_add_u32 v5, v1, 4, s8
  s_lshl_b32 s8, s3, 11
  s_add_u32 s8, s8, 57344
  v_lshl_add_u32 v6, v1, 4, s8
  v_lshrrev_b32 v3, 4, v1
  v_lshlrev_b32 v3, 3, v3
  v_bfe_u32 v20, v1, 2, 2
  v_add_lshl_u32 v20, v20, v3, 7
  v_and_b32 v3, 3, v1
  v_lshl_add_u32 v20, v3, 3, v20
  s_lshl_b32 s8, s3, 5
  s_add_u32 s8, s8, 32768
  v_add_u32 v20, s8, v20
  s_lshl_b32 s8, s5, 2
  s_add_u32 s8, s8, s3
  s_lshl_b32 s8, s8, 10
  s_add_u32 s8, s8, s95
  v_lshl_add_u32 v22, v1, 4, s8
  v_add_u32 v23, 32768, v22
  s_cmp_lt_u32 s5, 2
  s_cselect_b32 s9, 8, 4
  s_cmp_lt_u32 s4, s9
  s_cselect_b32 s85, 1, 0
  s_cselect_b32 s10, s4, 0
  s_lshr_b32 s8, s10, 2
  s_lshl_b32 s8, s8, 3
  s_add_u32 s8, s8, s5
  s_lshl_b32 s8, s8, 2
  s_add_u32 s8, s8, s3
  s_and_b32 s10, s10, 3
  s_lshl_b32 s9, s8, 10
  s_lshl_b32 s11, s10, 8
  s_add_u32 s9, s9, s11
  v_lshrrev_b32 v3, 4, v1
  v_mul_u32_u24 v8, 40960, v3
  v_add_u32 v8, s9, v8
  v_and_b32 v3, 15, v1
  v_lshl_add_u32 v8, v3, 4, v8
  s_lshl_b32 s8, s8, 5
  v_lshl_add_u32 v4, v3, 1, s8
  s_mul_i32 s10, s10, 1280
  v_add_u32 v211, s10, v4
  v_add_u32 v92, 3145728, v8
  v_add_u32 v93, 3309568, v8
  v_add_u32 v94, 3473408, v8
  v_add_u32 v95, 3637248, v8
  v_add_u32 v96, 3801088, v8
  v_add_u32 v97, 3964928, v8
  v_add_u32 v98, 4128768, v8
  v_add_u32 v99, 4292608, v8
  s_cmp_eq_u32 s85, 0
  s_cbranch_scc1 L_nofin1
  global_load_ushort v206, v211, s[16:17]
  global_load_ushort v207, v4, s[34:35]
  s_waitcnt vmcnt(0)
  v_lshlrev_b32 v206, 16, v206
  v_lshlrev_b32 v207, 16, v207
L_nofin1:
  v_mov_b32 v4, 2048
  s_mov_b32 s79, 8388608
L_rows:
  ds_read_b32 v3, v4 offset:0
  s_waitcnt lgkmcnt(0)
  v_readfirstlane_b32 s8, v3
  s_sub_u32 s79, s79, 1
  s_cselect_b32 s8, 4, s8
  s_cmp_ge_u32 s8, 4
  s_cbranch_scc1 L_rowsok
  s_sleep 16
  s_branch L_rows
L_rowsok:
  v_bfe_u32 v3, v1, 2, 2
  v_lshrrev_b32 v4, 4, v1
  v_lshlrev_b32 v4, 4, v4
  v_lshl_add_u32 v21, v3, 9, v4
  ds_read_b128 v[24:27], v21 offset:384
  ds_read_b128 v[28:31], v21 offset:448
  v_mul_u32_u24 v21, 384, v3
  v_add_u32 v21, v21, v4
  s_mov_b32 s6, 0
  s_mov_b32 s7, 0
  s_mov_b32 s63, 0
  s_add_u32 s8, s62, 0
  buffer_load_dwordx4 v[140:143], v2, s[44:47], s8 offen offset:0 nt
  s_add_u32 s8, s62, 10240
  buffer_load_dwordx4 v[144:147], v2, s[44:47], s8 offen offset:0 nt
  s_cmp_lt_u32 s5, 2
  s_cbranch_scc0 L_j01_1
  s_add_u32 s8, s84, 0
  buffer_load_dwordx4 v[60:63], v2, s[80:83], s8 offen offset:1024 nt
  s_add_u32 s8, s84, 10240
  buffer_load_dwordx4 v[64:67], v2, s[80:83], s8 offen offset:1024 nt
  s_add_u32 s8, s84, 20480
  buffer_load_dwordx4 v[68:71], v2, s[80:83], s8 offen offset:1024 nt
  s_add_u32 s8, s84, 30720
  buffer_load_dwordx4 v[72:75], v2, s[80:83], s8 offen offset:1024 nt
  s_add_u32 s8, s84, 40960
  buffer_load_dwordx4 v[76:79], v2, s[80:83], s8 offen offset:1024 nt
  s_add_u32 s8, s84, 51200
  buffer_load_dwordx4 v[80:83], v2, s[80:83], s8 offen offset:1024 nt
  s_add_u32 s8, s62, 0
  buffer_load_dwordx4 v[84:87], v2, s[44:47], s8 offen offset:1024 nt
  s_add_u32 s8, s62, 10240
  buffer_load_dwordx4 v[88:91], v2, s[44:47], s8 offen offset:1024 nt
L_j01_1:
  s_waitcnt vmcnt(0)
  ds_write_b128 v6, v[140:143] offset:0
  ds_write_b128 v6, v[144:147] offset:1024
  s_cmp_lt_u32 s5, 2
  s_cbranch_scc0 L_j01_2
  ds_write_b128 v5, v[60:63] offset:32768
  ds_write_b128 v5, v[64:67] offset:33792
  ds_write_b128 v5, v[68:71] offset:34816
  ds_write_b128 v5, v[72:75] offset:35840
  ds_write_b128 v5, v[76:79] offset:36864
  ds_write_b128 v5, v[80:83] offset:37888
  ds_write_b128 v6, v[84:87] offset:32768
  ds_write_b128 v6, v[88:91] offset:33792
L_j01_2:
  v_mov_b32 v4, 2048
  s_mov_b64 exec, 1
  ds_add_u32 v4, v7 offset:20
  s_mov_b64 exec, -1
  v_mov_b32 v4, 2048
  s_mov_b32 s79, 8388608
L_rdy0:
  ds_read_b32 v3, v4 offset:20
  s_waitcnt lgkmcnt(0)
  v_readfirstlane_b32 s8, v3
  s_sub_u32 s79, s79, 1
  s_cselect_b32 s8, 4, s8
  s_cmp_ge_u32 s8, 4
  s_cbranch_scc1 L_rdy0ok
  s_sleep 4
  s_branch L_rdy0
L_rdy0ok:
  ds_read_b64_tr_b16 v[212:213], v20 offset:24576
  ds_read_b64_tr_b16 v[214:215], v20 offset:25088
  ds_read_b64_tr_b16 v[216:217], v20 offset:28672
  ds_read_b64_tr_b16 v[218:219], v20 offset:29184
  s_cmp_lt_u32 s5, 2
  s_cbranch_scc0 L_j01_3
  ds_read_b64_tr_b16 v[140:141], v20 offset:32768
  ds_read_b64_tr_b16 v[142:143], v20 offset:33280
  ds_read_b64_tr_b16 v[144:145], v20 offset:36864
  ds_read_b64_tr_b16 v[146:147], v20 offset:37376
  ds_read_b64_tr_b16 v[148:149], v20 offset:40960
  ds_read_b64_tr_b16 v[150:151], v20 offset:41472
  ds_read_b64_tr_b16 v[152:153], v20 offset:45056
  ds_read_b64_tr_b16 v[154:155], v20 offset:45568
  ds_read_b64_tr_b16 v[156:157], v20 offset:49152
  ds_read_b64_tr_b16 v[158:159], v20 offset:49664
  ds_read_b64_tr_b16 v[160:161], v20 offset:53248
  ds_read_b64_tr_b16 v[162:163], v20 offset:53760
  ds_read_b64_tr_b16 v[220:221], v20 offset:57344
  ds_read_b64_tr_b16 v[222:223], v20 offset:57856
  ds_read_b64_tr_b16 v[224:225], v20 offset:61440
  ds_read_b64_tr_b16 v[226:227], v20 offset:61952
L_j01_3:
  s_waitcnt lgkmcnt(0)
  v_mfma_f32_16x16x32_bf16 v[8:11], v[24:27], v[212:215], 0
  v_mfma_f32_16x16x32_bf16 v[8:11], v[28:31], v[216:219], v[8:11]
  v_mfma_f32_16x16x32_bf16 v[12:15], v[24:27], v[220:223], 0
  v_mfma_f32_16x16x32_bf16 v[12:15], v[28:31], v[224:227], v[12:15]
  s_cmp_lt_u32 s4, 24
  s_cselect_b32 s8, -1, 0
  s_nop 6
  v_and_b32 v253, s8, v8
  v_xor_b32 v255, s94, v253
  v_and_b32 v197, s8, v12
  v_xor_b32 v199, s94, v197
  v_mov_b32 v4, 2048
  s_mov_b32 s79, 8388608
L_nl:
  ds_read_b32 v3, v4 offset:12
  s_waitcnt lgkmcnt(0)
  v_readfirstlane_b32 s8, v3
  s_sub_u32 s79, s79, 1
  s_cselect_b32 s8, 1, s8
  s_cmp_ge_u32 s8, 1
  s_cbranch_scc1 L_nlok
  s_sleep 6
  s_branch L_nl
L_nlok:
  s_setprio 3
  s_add_u32 s8, s84, 0
  buffer_load_dwordx4 v[116:119], v2, s[80:83], s8 offen offset:0 nt
  s_add_u32 s8, s84, 10240
  buffer_load_dwordx4 v[120:123], v2, s[80:83], s8 offen offset:0 nt
  s_add_u32 s8, s84, 20480
  buffer_load_dwordx4 v[124:127], v2, s[80:83], s8 offen offset:0 nt
  s_add_u32 s8, s84, 30720
  buffer_load_dwordx4 v[128:131], v2, s[80:83], s8 offen offset:0 nt
  s_add_u32 s8, s84, 40960
  buffer_load_dwordx4 v[132:135], v2, s[80:83], s8 offen offset:0 nt
  s_add_u32 s8, s84, 51200
  buffer_load_dwordx4 v[136:139], v2, s[80:83], s8 offen offset:0 nt
  s_cmp_eq_u32 s3, 3
  s_cbranch_scc1 L_fl3
  v_mov_b32 v4, 2048
  s_mov_b32 s79, 8388608
L_fl1:
  ds_read_b32 v3, v4 offset:12
  s_waitcnt lgkmcnt(0)
  v_readfirstlane_b32 s8, v3
  s_sub_u32 s79, s79, 1
  s_cselect_b32 s8, 1, s8
  s_cmp_ge_u32 s8, 1
  s_cbranch_scc1 L_fl1ok
  s_sleep 2
  s_branch L_fl1
L_fl1ok:
  s_branch L_fl2ok
L_fl3:
  v_mov_b32 v4, 2048
  s_mov_b32 s79, 8388608
L_fl2:
  ds_read_b32 v3, v4 offset:12
  s_waitcnt lgkmcnt(0)
  v_readfirstlane_b32 s8, v3
  s_sub_u32 s79, s79, 1
  s_cselect_b32 s8, 2, s8
  s_cmp_ge_u32 s8, 2
  s_cbranch_scc1 L_fl2ok
  s_sleep 2
  s_branch L_fl2
L_fl2ok:
  s_setprio 3
  s_mov_b32 s79, 524288
L_rpoll:
  global_load_dwordx4 v[44:47], v36, s[40:41] sc1
  s_bitcmp1_b32 s6, 0
  s_cbranch_scc0 L_rs0
  global_load_dwordx4 v[164:167], v37, s[40:41] offset:0 sc1
L_rs0:
  s_bitcmp1_b32 s6, 1
  s_cbranch_scc0 L_rs1
  global_load_dwordx4 v[168:171], v37, s[40:41] offset:1024 sc1
L_rs1:
  s_bitcmp1_b32 s6, 2
  s_cbranch_scc0 L_rs2
  global_load_dwordx4 v[172:175], v37, s[40:41] offset:2048 sc1
L_rs2:
  s_bitcmp1_b32 s6, 3
  s_cbranch_scc0 L_rs3
  global_load_dwordx4 v[176:179], v37, s[40:41] offset:3072 sc1
L_rs3:
  s_bitcmp1_b32 s6, 4
  s_cbranch_scc0 L_rs4
  global_load_dwordx4 v[180:183], v38, s[40:41] offset:0 sc1
L_rs4:
  s_bitcmp1_b32 s6, 5
  s_cbranch_scc0 L_rs5
  global_load_dwordx4 v[184:187], v38, s[40:41] offset:1024 sc1
L_rs5:
  s_bitcmp1_b32 s6, 6
  s_cbranch_scc0 L_rs6
  global_load_dwordx4 v[188:191], v38, s[40:41] offset:2048 sc1
L_rs6:
  s_bitcmp1_b32 s6, 7
  s_cbranch_scc0 L_rs7
  global_load_dwordx4 v[192:195], v38, s[40:41] offset:3072 sc1
L_rs7:
  s_cmp_eq_u32 s63, 1
  s_cbranch_scc0 L_nofr
  s_mov_b32 s11, s79
  s_call_b64 s[54:55], L_dofr
  s_mov_b32 s79, s11
L_nofr:
  s_waitcnt vmcnt(0)
  s_cmp_eq_u32 s63, 0
  s_cbranch_scc0 L_nost
  ds_write_b128 v5, v[116:119] offset:0
  ds_write_b128 v5, v[120:123] offset:1024
  ds_write_b128 v5, v[124:127] offset:2048
  ds_write_b128 v5, v[128:131] offset:3072
  ds_write_b128 v5, v[132:135] offset:4096
  ds_write_b128 v5, v[136:139] offset:5120
  v_mov_b32 v4, 2048
  s_mov_b64 exec, 1
  ds_add_u32 v4, v7 offset:4
  s_mov_b64 exec, -1
  s_mov_b32 s63, 1
L_nost:
  v_bitop3_b32 v48, v44, v45, v46 bitop3:0x96
  v_cmp_eq_u32 vcc, s78, v48
  s_and_b32 s12, vcc_lo, 0xff
  s_bitcmp1_b32 s6, 0
  s_cbranch_scc0 L_rv0
  v_bitop3_b32 v8, v164, v165, v166 bitop3:0x96
  v_xor_b32 v8, v8, v167
  v_cmp_ne_u32 vcc, s78, v8
  s_cbranch_vccnz L_rv0
  s_bitset1_b32 s7, 0
L_rv0:
  s_bitcmp1_b32 s6, 1
  s_cbranch_scc0 L_rv1
  v_bitop3_b32 v8, v168, v169, v170 bitop3:0x96
  v_xor_b32 v8, v8, v171
  v_cmp_ne_u32 vcc, s78, v8
  s_cbranch_vccnz L_rv1
  s_bitset1_b32 s7, 1
L_rv1:
  s_bitcmp1_b32 s6, 2
  s_cbranch_scc0 L_rv2
  v_bitop3_b32 v8, v172, v173, v174 bitop3:0x96
  v_xor_b32 v8, v8, v175
  v_cmp_ne_u32 vcc, s78, v8
  s_cbranch_vccnz L_rv2
  s_bitset1_b32 s7, 2
L_rv2:
  s_bitcmp1_b32 s6, 3
  s_cbranch_scc0 L_rv3
  v_bitop3_b32 v8, v176, v177, v178 bitop3:0x96
  v_xor_b32 v8, v8, v179
  v_cmp_ne_u32 vcc, s78, v8
  s_cbranch_vccnz L_rv3
  s_bitset1_b32 s7, 3
L_rv3:
  s_bitcmp1_b32 s6, 4
  s_cbranch_scc0 L_rv4
  v_bitop3_b32 v8, v180, v181, v182 bitop3:0x96
  v_xor_b32 v8, v8, v183
  v_cmp_ne_u32 vcc, s78, v8
  s_cbranch_vccnz L_rv4
  s_bitset1_b32 s7, 4
L_rv4:
  s_bitcmp1_b32 s6, 5
  s_cbranch_scc0 L_rv5
  v_bitop3_b32 v8, v184, v185, v186 bitop3:0x96
  v_xor_b32 v8, v8, v187
  v_cmp_ne_u32 vcc, s78, v8
  s_cbranch_vccnz L_rv5
  s_bitset1_b32 s7, 5
L_rv5:
  s_bitcmp1_b32 s6, 6
  s_cbranch_scc0 L_rv6
  v_bitop3_b32 v8, v188, v189, v190 bitop3:0x96
  v_xor_b32 v8, v8, v191
  v_cmp_ne_u32 vcc, s78, v8
  s_cbranch_vccnz L_rv6
  s_bitset1_b32 s7, 6
L_rv6:
  s_bitcmp1_b32 s6, 7
  s_cbranch_scc0 L_rv7
  v_bitop3_b32 v8, v192, v193, v194 bitop3:0x96
  v_xor_b32 v8, v8, v195
  v_cmp_ne_u32 vcc, s78, v8
  s_cbranch_vccnz L_rv7
  s_bitset1_b32 s7, 7
L_rv7:
  s_and_b32 s8, s7, s12
  s_cmp_eq_u32 s8, 0xff
  s_cbranch_scc1 L_rok
  s_bcnt1_i32_b32 s8, s12
  s_cmp_ge_u32 s8, 4
  s_cselect_b32 s6, 0xff, s12
  s_cbranch_scc1 L_rfast
  s_sleep 4
L_rfast:
  s_andn2_b32 s6, s6, s7
  s_sub_u32 s79, s79, 1
  s_cmp_lg_u32 s79, 0
  s_cbranch_scc1 L_rpoll
L_rok:
  v_mov_b32 v48, v44
  s_nop 1
  v_max_f32_dpp v48, v48, v48 quad_perm:[1,0,3,2] row_mask:0xf bank_mask:0xf
  s_nop 1
  v_max_f32_dpp v48, v48, v48 quad_perm:[2,3,0,1] row_mask:0xf bank_mask:0xf
  s_nop 1
  v_max_f32_dpp v48, v48, v48 row_half_mirror row_mask:0xf bank_mask:0xf
  v_sub_f32 v49, v44, v48
  v_mul_f32 v49, 0x3fb8aa3b, v49
  v_exp_f32 v49, v49
  s_nop 0
  v_mul_f32 v50, v49, v45
  v_readlane_b32 s56, v49, 0
  v_readlane_b32 s57, v49, 1
  v_readlane_b32 s58, v49, 2
  v_readlane_b32 s59, v49, 3
  v_readlane_b32 s60, v49, 4
  v_readlane_b32 s61, v49, 5
  v_readlane_b32 s62, v49, 6
  v_readlane_b32 s63, v49, 7
  v_add_f32_dpp v50, v50, v50 quad_perm:[1,0,3,2] row_mask:0xf bank_mask:0xf
  v_pk_mul_f32 v[52:53], v[164:165], s[56:57] op_sel_hi:[1,0]
  v_mul_f32 v54, s56, v166
  v_add_f32_dpp v50, v50, v50 quad_perm:[2,3,0,1] row_mask:0xf bank_mask:0xf
  v_pk_fma_f32 v[52:53], v[168:169], s[56:57], v[52:53] op_sel:[0,1,0] op_sel_hi:[1,1,1]
  v_fmac_f32 v54, s57, v170
  v_add_f32_dpp v50, v50, v50 row_half_mirror row_mask:0xf bank_mask:0xf
  v_pk_fma_f32 v[52:53], v[172:173], s[58:59], v[52:53] op_sel_hi:[1,0,1]
  v_fmac_f32 v54, s58, v174
  v_rcp_f32 v51, v50
  v_pk_fma_f32 v[52:53], v[176:177], s[58:59], v[52:53] op_sel:[0,1,0] op_sel_hi:[1,1,1]
  v_fmac_f32 v54, s59, v178
  v_pk_fma_f32 v[52:53], v[180:181], s[60:61], v[52:53] op_sel_hi:[1,0,1]
  v_fmac_f32 v54, s60, v182
  v_pk_fma_f32 v[52:53], v[184:185], s[60:61], v[52:53] op_sel:[0,1,0] op_sel_hi:[1,1,1]
  v_fmac_f32 v54, s61, v186
  v_pk_fma_f32 v[52:53], v[188:189], s[62:63], v[52:53] op_sel_hi:[1,0,1]
  v_fmac_f32 v54, s62, v190
  v_pk_fma_f32 v[52:53], v[192:193], s[62:63], v[52:53] op_sel:[0,1,0] op_sel_hi:[1,1,1]
  v_fmac_f32 v54, s63, v194
  v_mul_f32 v56, v52, v51
  v_mul_f32 v57, v53, v51
  v_mul_f32 v58, v54, v51
  v_fma_f32 v52, -v56, v50, v52
  v_fma_f32 v53, -v57, v50, v53
  v_fma_f32 v54, -v58, v50, v54
  v_fma_f32 v52, v52, v51, v56
  v_fma_f32 v53, v53, v51, v57
  v_fma_f32 v54, v54, v51, v58
  v_cvt_pk_bf16_f32 v56, v52, v53
  v_cvt_pk_bf16_f32 v57, v54, v54
  ds_write_b16 v39, v56 offset:2560
  ds_write_b16_d16_hi v39, v56 offset:2688
  ds_write_b16 v39, v57 offset:2816
  s_waitcnt lgkmcnt(0)
  s_barrier
  ds_read_b128 v[228:231], v21 offset:2560
  ds_read_b128 v[232:235], v21 offset:2624
  ds_read_b128 v[236:239], v21 offset:2688
  ds_read_b128 v[240:243], v21 offset:2752
  ds_read_b128 v[244:247], v21 offset:2816
  ds_read_b128 v[248:251], v21 offset:2880
  s_waitcnt lgkmcnt(5)
  v_mfma_f32_16x16x32_bf16 v[8:11], v[228:231], v[116:119], 0
  v_mfma_f32_16x16x32_bf16 v[12:15], v[228:231], v[140:143], 0
  s_waitcnt lgkmcnt(4)
  v_mfma_f32_16x16x32_bf16 v[8:11], v[232:235], v[120:123], v[8:11]
  v_mfma_f32_16x16x32_bf16 v[12:15], v[232:235], v[144:147], v[12:15]
  s_waitcnt lgkmcnt(3)
  v_mfma_f32_16x16x32_bf16 v[8:11], v[236:239], v[124:127], v[8:11]
  v_mfma_f32_16x16x32_bf16 v[12:15], v[236:239], v[148:151], v[12:15]
  s_waitcnt lgkmcnt(2)
  v_mfma_f32_16x16x32_bf16 v[8:11], v[240:243], v[128:131], v[8:11]
  v_mfma_f32_16x16x32_bf16 v[12:15], v[240:243], v[152:155], v[12:15]
  s_waitcnt lgkmcnt(1)
  v_mfma_f32_16x16x32_bf16 v[8:11], v[244:247], v[132:135], v[8:11]
  v_mfma_f32_16x16x32_bf16 v[12:15], v[244:247], v[156:159], v[12:15]
  s_waitcnt lgkmcnt(0)
  v_mfma_f32_16x16x32_bf16 v[8:11], v[248:251], v[136:139], v[8:11]
  v_mfma_f32_16x16x32_bf16 v[12:15], v[248:251], v[160:163], v[12:15]
  s_cmp_lt_u32 s5, 2
  s_nop 5
  v_mov_b32 v252, v8
  v_xor_b32 v254, v8, v255
  global_store_dwordx4 v22, v[252:255], s[40:41] sc1
  s_cbranch_scc0 L_ya_done
  v_mov_b32 v196, v12
  v_xor_b32 v198, v12, v199
  global_store_dwordx4 v23, v[196:199], s[40:41] sc1
L_ya_done:
  s_cmp_eq_u32 s85, 0
  s_cbranch_scc1 L_svc_end
  s_mov_b32 s79, 524288
  s_mov_b32 s6, 0xff
L_yap:
  s_bitcmp1_b32 s6, 0
  s_cbranch_scc0 L_ys0
  global_load_dwordx4 v[60:63], v92, s[40:41] sc1
L_ys0:
  s_bitcmp1_b32 s6, 1
  s_cbranch_scc0 L_ys1
  global_load_dwordx4 v[64:67], v93, s[40:41] sc1
L_ys1:
  s_bitcmp1_b32 s6, 2
  s_cbranch_scc0 L_ys2
  global_load_dwordx4 v[68:71], v94, s[40:41] sc1
L_ys2:
  s_bitcmp1_b32 s6, 3
  s_cbranch_scc0 L_ys3
  global_load_dwordx4 v[72:75], v95, s[40:41] sc1
L_ys3:
  s_bitcmp1_b32 s6, 4
  s_cbranch_scc0 L_ys4
  global_load_dwordx4 v[76:79], v96, s[40:41] sc1
L_ys4:
  s_bitcmp1_b32 s6, 5
  s_cbranch_scc0 L_ys5
  global_load_dwordx4 v[80:83], v97, s[40:41] sc1
L_ys5:
  s_bitcmp1_b32 s6, 6
  s_cbranch_scc0 L_ys6
  global_load_dwordx4 v[84:87], v98, s[40:41] sc1
L_ys6:
  s_bitcmp1_b32 s6, 7
  s_cbranch_scc0 L_ys7
  global_load_dwordx4 v[88:91], v99, s[40:41] sc1
L_ys7:
  s_waitcnt vmcnt(0)
  v_bitop3_b32 v8, v60, v61, v62 bitop3:0x96
  v_cmp_ne_u32 vcc, s94, v8
  s_cbranch_vccnz L_yv0
  s_bitset0_b32 s6, 0
L_yv0:
  v_bitop3_b32 v9, v64, v65, v66 bitop3:0x96
  v_cmp_ne_u32 vcc, s94, v9
  s_cbranch_vccnz L_yv1
  s_bitset0_b32 s6, 1
L_yv1:
  v_bitop3_b32 v8, v68, v69, v70 bitop3:0x96
  v_cmp_ne_u32 vcc, s94, v8
  s_cbranch_vccnz L_yv2
  s_bitset0_b32 s6, 2
L_yv2:
  v_bitop3_b32 v9, v72, v73, v74 bitop3:0x96
  v_cmp_ne_u32 vcc, s94, v9
  s_cbranch_vccnz L_yv3
  s_bitset0_b32 s6, 3
L_yv3:
  v_bitop3_b32 v8, v76, v77, v78 bitop3:0x96
  v_cmp_ne_u32 vcc, s94, v8
  s_cbranch_vccnz L_yv4
  s_bitset0_b32 s6, 4
L_yv4:
  v_bitop3_b32 v9, v80, v81, v82 bitop3:0x96
  v_cmp_ne_u32 vcc, s94, v9
  s_cbranch_vccnz L_yv5
  s_bitset0_b32 s6, 5
L_yv5:
  v_bitop3_b32 v8, v84, v85, v86 bitop3:0x96
  v_cmp_ne_u32 vcc, s94, v8
  s_cbranch_vccnz L_yv6
  s_bitset0_b32 s6, 6
L_yv6:
  v_bitop3_b32 v9, v88, v89, v90 bitop3:0x96
  v_cmp_ne_u32 vcc, s94, v9
  s_cbranch_vccnz L_yv7
  s_bitset0_b32 s6, 7
L_yv7:
  s_cmp_eq_u32 s6, 0
  s_cbranch_scc1 L_yapok
  s_sleep 1
  s_sub_u32 s79, s79, 1
  s_cmp_lg_u32 s79, 0
  s_cbranch_scc1 L_yap
L_yapok:
  v_pk_add_f32 v[60:61], v[60:61], v[64:65]
  v_pk_add_f32 v[68:69], v[68:69], v[72:73]
  v_pk_add_f32 v[76:77], v[76:77], v[80:81]
  v_pk_add_f32 v[84:85], v[84:85], v[88:89]
  v_pk_add_f32 v[60:61], v[60:61], v[68:69]
  v_pk_add_f32 v[76:77], v[76:77], v[84:85]
  v_pk_add_f32 v[60:61], v[60:61], v[76:77]
  v_mov_b32 v62, v60
  v_mov_b32 v63, v61
  s_nop 0
  v_permlane16_swap_b32 v60, v62
  v_permlane16_swap_b32 v61, v63
  s_nop 0
  v_pk_add_f32 v[60:61], v[60:61], v[62:63]
  v_mov_b32 v62, v60
  v_mov_b32 v63, v61
  s_nop 0
  v_permlane32_swap_b32 v60, v62
  v_permlane32_swap_b32 v61, v63
  s_nop 0
  v_pk_add_f32 v[60:61], v[60:61], v[62:63]
  s_mov_b32 exec_lo, 0xffff
  s_mov_b32 exec_hi, 0x0
  v_cvt_pk_bf16_f32 v62, v60, v61
  v_lshlrev_b32 v60, 16, v62
  v_and_b32 v61, s15, v62
  v_pk_add_f32 v[60:61], v[60:61], v[206:207]
  v_cvt_pk_bf16_f32 v62, v60, v61
  v_lshlrev_b32 v60, 16, v62
  v_and_b32 v61, s15, v62
  v_add_f32 v60, v60, v61
  v_cvt_pk_bf16_f32 v60, v60, v60
  global_store_short v211, v60, s[36:37]
  s_mov_b64 exec, -1
  s_or_b32 s8, s2, s3
  s_cmp_eq_u32 s8, 0
  s_cbranch_scc0 L_svc_end
  v_mov_b32 v3, 0
  v_mov_b32 v4, s78
  s_mov_b64 exec, 1
  global_store_dword v3, v4, s[40:41] sc1
  s_mov_b64 exec, -1
  s_branch L_svc_end
L_dofr:
  v_mov_b32 v4, 2048
  s_mov_b32 s79, 8388608
L_rdy:
  ds_read_b32 v3, v4 offset:4
  s_waitcnt lgkmcnt(0)
  v_readfirstlane_b32 s8, v3
  s_sub_u32 s79, s79, 1
  s_cselect_b32 s8, 4, s8
  s_cmp_ge_u32 s8, 4
  s_cbranch_scc0 L_rdy
L_rdyok:
  ds_read_b64_tr_b16 v[116:117], v20 offset:0
  ds_read_b64_tr_b16 v[118:119], v20 offset:512
  ds_read_b64_tr_b16 v[120:121], v20 offset:4096
  ds_read_b64_tr_b16 v[122:123], v20 offset:4608
  ds_read_b64_tr_b16 v[124:125], v20 offset:8192
  ds_read_b64_tr_b16 v[126:127], v20 offset:8704
  ds_read_b64_tr_b16 v[128:129], v20 offset:12288
  ds_read_b64_tr_b16 v[130:131], v20 offset:12800
  ds_read_b64_tr_b16 v[132:133], v20 offset:16384
  ds_read_b64_tr_b16 v[134:135], v20 offset:16896
  ds_read_b64_tr_b16 v[136:137], v20 offset:20480
  ds_read_b64_tr_b16 v[138:139], v20 offset:20992
  s_waitcnt lgkmcnt(0)
  s_mov_b32 s63, 2
  s_setpc_b64 s[54:55]
L_svc_end:
  s_endpgm
L_stream:
  s_sub_u32 s85, s3, 4
  v_and_b32 v3, 7, v1
  v_lshrrev_b32 v4, 3, v1
  v_lshrrev_b32 v0, 2, v3
  v_and_b32 v3, 3, v3
  v_mul_u32_u24 v252, 384, v3
  v_lshl_add_u32 v252, v4, 4, v252
  s_mul_i32 s43, s4, 3145728
  s_mov_b32 s56, s43
  s_lshl_b32 s58, s5, 6
  s_add_u32 s58, s58, s85
  s_mov_b32 s7, s58
  s_mov_b32 s80, 4
  s_waitcnt lgkmcnt(0)
  s_load_dword s78, s[40:41], 0
  s_mov_b32 s44, s18
  s_mov_b32 s45, s19
  s_mov_b32 s46, 402653184
  s_mov_b32 s47, 0x20000
  s_lshr_b32 s8, s7, 6
  s_mul_i32 s8, s8, 393216
  s_and_b32 s9, s7, 63
  s_mul_i32 s10, s9, 3121
  s_lshr_b32 s10, s10, 16
  s_mul_i32 s10, s10, 22
  s_add_u32 s10, s10, s9
  s_cmp_eq_u32 s9, 63
  s_cselect_b32 s10, 42, s10
  s_cselect_b32 s57, 43, 21
  s_mul_i32 s57, s57, 3072
  s_mul_i32 s10, s10, 3072
  s_add_u32 s12, s56, s8
  s_add_u32 s12, s12, s10
  v_mad_u32_u24 v2, v0, s57, v252
  s_add_u32 s7, s7, s80
  buffer_load_dwordx4 v[60:63], v2, s[44:47], s12 offen offset:0 nt
  buffer_load_dwordx4 v[64:67], v2, s[44:47], s12 offen offset:128 nt
  buffer_load_dwordx4 v[68:71], v2, s[44:47], s12 offen offset:256 nt
  buffer_load_dwordx4 v[72:75], v2, s[44:47], s12 offen offset:1536 nt
  buffer_load_dwordx4 v[76:79], v2, s[44:47], s12 offen offset:1664 nt
  buffer_load_dwordx4 v[80:83], v2, s[44:47], s12 offen offset:1792 nt
  s_lshr_b32 s8, s7, 6
  s_mul_i32 s8, s8, 393216
  s_and_b32 s9, s7, 63
  s_mul_i32 s10, s9, 3121
  s_lshr_b32 s10, s10, 16
  s_mul_i32 s10, s10, 22
  s_add_u32 s10, s10, s9
  s_cmp_eq_u32 s9, 63
  s_cselect_b32 s10, 42, s10
  s_cselect_b32 s57, 43, 21
  s_mul_i32 s57, s57, 3072
  s_mul_i32 s10, s10, 3072
  s_add_u32 s12, s56, s8
  s_add_u32 s12, s12, s10
  v_mad_u32_u24 v2, v0, s57, v252
  s_add_u32 s7, s7, s80
  buffer_load_dwordx4 v[84:87], v2, s[44:47], s12 offen offset:0 nt
  buffer_load_dwordx4 v[88:91], v2, s[44:47], s12 offen offset:128 nt
  buffer_load_dwordx4 v[92:95], v2, s[44:47], s12 offen offset:256 nt
  buffer_load_dwordx4 v[96:99], v2, s[44:47], s12 offen offset:1536 nt
  buffer_load_dwordx4 v[100:103], v2, s[44:47], s12 offen offset:1664 nt
  buffer_load_dwordx4 v[104:107], v2, s[44:47], s12 offen offset:1792 nt
  s_lshr_b32 s8, s7, 6
  s_mul_i32 s8, s8, 393216
  s_and_b32 s9, s7, 63
  s_mul_i32 s10, s9, 3121
  s_lshr_b32 s10, s10, 16
  s_mul_i32 s10, s10, 22
  s_add_u32 s10, s10, s9
  s_cmp_eq_u32 s9, 63
  s_cselect_b32 s10, 42, s10
  s_cselect_b32 s57, 43, 21
  s_mul_i32 s57, s57, 3072
  s_mul_i32 s10, s10, 3072
  s_add_u32 s12, s56, s8
  s_add_u32 s12, s12, s10
  v_mad_u32_u24 v2, v0, s57, v252
  s_add_u32 s7, s7, s80
  s_waitcnt vmcnt(2)
  buffer_load_dwordx4 v[108:111], v2, s[44:47], s12 offen offset:0 nt
  buffer_load_dwordx4 v[112:115], v2, s[44:47], s12 offen offset:128 nt
  buffer_load_dwordx4 v[116:119], v2, s[44:47], s12 offen offset:256 nt
  buffer_load_dwordx4 v[120:123], v2, s[44:47], s12 offen offset:1536 nt
  buffer_load_dwordx4 v[124:127], v2, s[44:47], s12 offen offset:1664 nt
  buffer_load_dwordx4 v[128:131], v2, s[44:47], s12 offen offset:1792 nt
  s_lshr_b32 s8, s7, 6
  s_mul_i32 s8, s8, 393216
  s_and_b32 s9, s7, 63
  s_mul_i32 s10, s9, 3121
  s_lshr_b32 s10, s10, 16
  s_mul_i32 s10, s10, 22
  s_add_u32 s10, s10, s9
  s_cmp_eq_u32 s9, 63
  s_cselect_b32 s10, 42, s10
  s_cselect_b32 s57, 43, 21
  s_mul_i32 s57, s57, 3072
  s_mul_i32 s10, s10, 3072
  s_add_u32 s12, s56, s8
  s_add_u32 s12, s12, s10
  v_mad_u32_u24 v2, v0, s57, v252
  s_add_u32 s7, s7, s80
  s_waitcnt vmcnt(2)
  buffer_load_dwordx4 v[132:135], v2, s[44:47], s12 offen offset:0 nt
  buffer_load_dwordx4 v[136:139], v2, s[44:47], s12 offen offset:128 nt
  buffer_load_dwordx4 v[140:143], v2, s[44:47], s12 offen offset:256 nt
  buffer_load_dwordx4 v[144:147], v2, s[44:47], s12 offen offset:1536 nt
  buffer_load_dwordx4 v[148:151], v2, s[44:47], s12 offen offset:1664 nt
  buffer_load_dwordx4 v[152:155], v2, s[44:47], s12 offen offset:1792 nt
  s_barrier
  s_barrier
  s_lshr_b32 s8, s7, 6
  s_mul_i32 s8, s8, 393216
  s_and_b32 s9, s7, 63
  s_mul_i32 s10, s9, 3121
  s_lshr_b32 s10, s10, 16
  s_mul_i32 s10, s10, 22
  s_add_u32 s10, s10, s9
  s_cmp_eq_u32 s9, 63
  s_cselect_b32 s10, 42, s10
  s_cselect_b32 s57, 43, 21
  s_mul_i32 s57, s57, 3072
  s_mul_i32 s10, s10, 3072
  s_add_u32 s12, s56, s8
  s_add_u32 s12, s12, s10
  v_mad_u32_u24 v2, v0, s57, v252
  s_add_u32 s7, s7, s80
  s_waitcnt vmcnt(2)
  buffer_load_dwordx4 v[156:159], v2, s[44:47], s12 offen offset:0 nt
  buffer_load_dwordx4 v[160:163], v2, s[44:47], s12 offen offset:128 nt
  buffer_load_dwordx4 v[164:167], v2, s[44:47], s12 offen offset:256 nt
  buffer_load_dwordx4 v[168:171], v2, s[44:47], s12 offen offset:1536 nt
  buffer_load_dwordx4 v[172:175], v2, s[44:47], s12 offen offset:1664 nt
  buffer_load_dwordx4 v[176:179], v2, s[44:47], s12 offen offset:1792 nt
  s_lshr_b32 s8, s7, 6
  s_mul_i32 s8, s8, 393216
  s_and_b32 s9, s7, 63
  s_mul_i32 s10, s9, 3121
  s_lshr_b32 s10, s10, 16
  s_mul_i32 s10, s10, 22
  s_add_u32 s10, s10, s9
  s_cmp_eq_u32 s9, 63
  s_cselect_b32 s10, 42, s10
  s_cselect_b32 s57, 43, 21
  s_mul_i32 s57, s57, 3072
  s_mul_i32 s10, s10, 3072
  s_add_u32 s12, s56, s8
  s_add_u32 s12, s12, s10
  v_mad_u32_u24 v2, v0, s57, v252
  s_add_u32 s7, s7, s80
  s_waitcnt vmcnt(2)
  buffer_load_dwordx4 v[180:183], v2, s[44:47], s12 offen offset:0 nt
  buffer_load_dwordx4 v[184:187], v2, s[44:47], s12 offen offset:128 nt
  buffer_load_dwordx4 v[188:191], v2, s[44:47], s12 offen offset:256 nt
  buffer_load_dwordx4 v[192:195], v2, s[44:47], s12 offen offset:1536 nt
  buffer_load_dwordx4 v[196:199], v2, s[44:47], s12 offen offset:1664 nt
  buffer_load_dwordx4 v[200:203], v2, s[44:47], s12 offen offset:1792 nt
  s_lshr_b32 s8, s7, 6
  s_mul_i32 s8, s8, 393216
  s_and_b32 s9, s7, 63
  s_mul_i32 s10, s9, 3121
  s_lshr_b32 s10, s10, 16
  s_mul_i32 s10, s10, 22
  s_add_u32 s10, s10, s9
  s_cmp_eq_u32 s9, 63
  s_cselect_b32 s10, 42, s10
  s_cselect_b32 s57, 43, 21
  s_mul_i32 s57, s57, 3072
  s_mul_i32 s10, s10, 3072
  s_add_u32 s12, s56, s8
  s_add_u32 s12, s12, s10
  v_mad_u32_u24 v2, v0, s57, v252
  s_add_u32 s7, s7, s80
  s_waitcnt vmcnt(2)
  buffer_load_dwordx4 v[204:207], v2, s[44:47], s12 offen offset:0 nt
  buffer_load_dwordx4 v[208:211], v2, s[44:47], s12 offen offset:128 nt
  buffer_load_dwordx4 v[212:215], v2, s[44:47], s12 offen offset:256 nt
  buffer_load_dwordx4 v[216:219], v2, s[44:47], s12 offen offset:1536 nt
  buffer_load_dwordx4 v[220:223], v2, s[44:47], s12 offen offset:1664 nt
  buffer_load_dwordx4 v[224:227], v2, s[44:47], s12 offen offset:1792 nt
  s_lshr_b32 s8, s7, 6
  s_mul_i32 s8, s8, 393216
  s_and_b32 s9, s7, 63
  s_mul_i32 s10, s9, 3121
  s_lshr_b32 s10, s10, 16
  s_mul_i32 s10, s10, 22
  s_add_u32 s10, s10, s9
  s_cmp_eq_u32 s9, 63
  s_cselect_b32 s10, 42, s10
  s_cselect_b32 s57, 43, 21
  s_mul_i32 s57, s57, 3072
  s_mul_i32 s10, s10, 3072
  s_add_u32 s12, s56, s8
  s_add_u32 s12, s12, s10
  v_mad_u32_u24 v2, v0, s57, v252
  s_add_u32 s7, s7, s80
  s_waitcnt vmcnt(2)
  buffer_load_dwordx4 v[228:231], v2, s[44:47], s12 offen offset:0 nt
  buffer_load_dwordx4 v[232:235], v2, s[44:47], s12 offen offset:128 nt
  buffer_load_dwordx4 v[236:239], v2, s[44:47], s12 offen offset:256 nt
  buffer_load_dwordx4 v[240:243], v2, s[44:47], s12 offen offset:1536 nt
  buffer_load_dwordx4 v[244:247], v2, s[44:47], s12 offen offset:1664 nt
  buffer_load_dwordx4 v[248:251], v2, s[44:47], s12 offen offset:1792 nt
  s_mov_b32 s48, s20
  s_mov_b32 s49, s21
  s_mov_b32 s50, 402653184
  s_mov_b32 s51, 0x20000
  s_mov_b32 s52, s18
  s_mov_b32 s53, s19
  s_mov_b32 s54, 402653184
  s_mov_b32 s55, 0x20000
  v_lshrrev_b32 v10, 4, v1
  v_lshlrev_b32 v10, 5, v10
  v_and_b32 v4, 1, v1
  v_lshl_add_u32 v10, v4, 4, v10
  v_mov_b32 v6, 1
  s_mul_i32 s8, s4, 4352
  s_add_u32 s8, s8, 8388608
  v_mov_b32 v11, s8
  s_mul_i32 s8, s85, 3584
  s_add_u32 s8, s8, 98304
  v_and_b32 v3, 15, v1
  v_lshl_add_u32 v253, v3, 2, s8
  v_and_b32 v3, 7, v1
  v_lshl_add_u32 v254, v3, 2, s8
  s_mov_b32 s42, 0
  s_mov_b32 s82, 0
  s_mov_b32 s83, 0
  s_mov_b32 s84, 0
  s_mov_b32 s95, 0
  s_mov_b32 s59, 0
  s_mov_b32 s60, 0x3fb8aa3b
  s_mov_b32 s61, 0x3fb8aa3b
  s_mov_b32 s86, 0xcccccccc
  s_mov_b32 s87, 0xcccccccc
  s_mov_b32 s88, 0xaaaaaaaa
  s_mov_b32 s89, 0xaaaaaaaa
  v_mov_b32 v7, 0xff61b1e6
  v_mov_b32 v8, 0
  v_mov_b32 v36, 0
  v_mov_b32 v37, 0
  v_mov_b32 v38, 0
  v_mov_b32 v39, 0
  v_mov_b32 v40, 0
  v_mov_b32 v41, 0
  v_mov_b32 v42, 0
  v_mov_b32 v43, 0
  v_mov_b32 v44, 0
  v_mov_b32 v45, 0
  v_mov_b32 v46, 0
  v_mov_b32 v47, 0
  v_mov_b32 v48, 0
  v_mov_b32 v49, 0
  v_mov_b32 v50, 0
  v_mov_b32 v51, 0
  v_mov_b32 v52, 0
  v_mov_b32 v53, 0
  v_mov_b32 v54, 0
  v_mov_b32 v55, 0
  v_mov_b32 v56, 0
  v_mov_b32 v57, 0
  v_mov_b32 v58, 0
  v_mov_b32 v59, 0
  s_waitcnt lgkmcnt(0)
  s_add_u32 s78, s78, 1
  s_addc_u32 s78, s78, 0
  s_cmp_eq_u32 s78, 0x80000001
  s_addc_u32 s78, s78, 0
L_kloop:
  s_bitcmp1_b32 s59, 0
  s_cbranch_scc1 L_sameq
  s_lshl_b32 s9, s59, 1
  s_add_u32 s9, s9, 2080
  v_mov_b32 v4, s9
  s_mov_b32 s79, 8388608
L_qf:
  ds_read_b32 v3, v4
  s_waitcnt lgkmcnt(0)
  v_readfirstlane_b32 s8, v3
  s_sub_u32 s79, s79, 1
  s_cselect_b32 s8, 1, s8
  s_cmp_ge_u32 s8, 1
  s_cbranch_scc1 L_qfok
  s_sleep 1
  s_branch L_qf
L_qfok:
  v_mov_b32 v4, 2048
  s_mov_b64 exec, 1
  ds_add_u32 v4, v6 offset:28
  s_mov_b64 exec, -1
  s_lshl_b32 s8, s59, 8
  v_add_u32 v3, s8, v10
  ds_read_b128 v[16:19], v3 offset:0
  ds_read_b128 v[20:23], v3 offset:128
  ds_read_b128 v[24:27], v3 offset:256
  s_waitcnt lgkmcnt(0)
L_sameq:
  s_add_u32 s8, s59, 1
  s_cmp_ge_u32 s8, 7
  s_cselect_b32 s52, s48, s44
  s_cselect_b32 s53, s49, s45
  s_cselect_b32 s9, 7, 0
  s_sub_u32 s8, s8, s9
  s_lshr_b32 s9, s8, 1
  s_mul_i32 s56, s9, 100663296
  s_add_u32 s56, s56, s43
  s_and_b32 s8, s8, 1
  s_lshl_b32 s8, s8, 5
  s_add_u32 s7, s58, s8
  s_waitcnt vmcnt(42)
  v_mfma_f32_16x16x32_bf16 v[28:31], v[16:19], v[60:63], 0
  v_mfma_f32_16x16x32_bf16 v[32:35], v[16:19], v[72:75], 0
  v_mfma_f32_16x16x32_bf16 v[28:31], v[20:23], v[64:67], v[28:31]
  v_mfma_f32_16x16x32_bf16 v[32:35], v[20:23], v[76:79], v[32:35]
  v_mfma_f32_16x16x32_bf16 v[28:31], v[24:27], v[68:71], v[28:31]
  v_mfma_f32_16x16x32_bf16 v[32:35], v[24:27], v[80:83], v[32:35]
  s_lshr_b32 s8, s7, 6
  s_mul_i32 s8, s8, 393216
  s_and_b32 s9, s7, 63
  s_mul_i32 s10, s9, 3121
  s_lshr_b32 s10, s10, 16
  s_mul_i32 s10, s10, 22
  s_add_u32 s10, s10, s9
  s_cmp_eq_u32 s9, 63
  s_cselect_b32 s10, 42, s10
  s_cselect_b32 s57, 43, 21
  s_mul_i32 s57, s57, 3072
  s_mul_i32 s10, s10, 3072
  s_add_u32 s12, s56, s8
  s_add_u32 s12, s12, s10
  v_mad_u32_u24 v2, v0, s57, v252
  s_add_u32 s7, s7, s80
  s_waitcnt vmcnt(2)
  buffer_load_dwordx4 v[60:63], v2, s[52:55], s12 offen offset:0 nt
  buffer_load_dwordx4 v[64:67], v2, s[52:55], s12 offen offset:128 nt
  buffer_load_dwordx4 v[68:71], v2, s[52:55], s12 offen offset:256 nt
  buffer_load_dwordx4 v[72:75], v2, s[52:55], s12 offen offset:1536 nt
  buffer_load_dwordx4 v[76:79], v2, s[52:55], s12 offen offset:1664 nt
  buffer_load_dwordx4 v[80:83], v2, s[52:55], s12 offen offset:1792 nt
  v_add_f32_dpp v255, v29, v28 row_ror:8 row_mask:0xf bank_mask:0x3
  v_add_f32_dpp v255, v32, v33 row_ror:8 row_mask:0xf bank_mask:0xc
  v_cvt_pk_bf16_f32 v3, v255, v255
  v_lshlrev_b32 v255, 16, v3
  v_mul_f32 v255, 0x3d93cd3a, v255
  v_cvt_pk_bf16_f32 v3, v255, v255
  v_lshlrev_b32 v255, 16, v3
  ds_write_b32 v253, v255 offset:0
  s_waitcnt vmcnt(42)
  v_mfma_f32_16x16x32_bf16 v[28:31], v[16:19], v[84:87], 0
  v_mfma_f32_16x16x32_bf16 v[32:35], v[16:19], v[96:99], 0
  v_mfma_f32_16x16x32_bf16 v[28:31], v[20:23], v[88:91], v[28:31]
  v_mfma_f32_16x16x32_bf16 v[32:35], v[20:23], v[100:103], v[32:35]
  v_mfma_f32_16x16x32_bf16 v[28:31], v[24:27], v[92:95], v[28:31]
  v_mfma_f32_16x16x32_bf16 v[32:35], v[24:27], v[104:107], v[32:35]
  s_lshr_b32 s8, s7, 6
  s_mul_i32 s8, s8, 393216
  s_and_b32 s9, s7, 63
  s_mul_i32 s10, s9, 3121
  s_lshr_b32 s10, s10, 16
  s_mul_i32 s10, s10, 22
  s_add_u32 s10, s10, s9
  s_cmp_eq_u32 s9, 63
  s_cselect_b32 s10, 42, s10
  s_cselect_b32 s57, 43, 21
  s_mul_i32 s57, s57, 3072
  s_mul_i32 s10, s10, 3072
  s_add_u32 s12, s56, s8
  s_add_u32 s12, s12, s10
  v_mad_u32_u24 v2, v0, s57, v252
  s_add_u32 s7, s7, s80
  s_waitcnt vmcnt(2)
  buffer_load_dwordx4 v[84:87], v2, s[52:55], s12 offen offset:0 nt
  buffer_load_dwordx4 v[88:91], v2, s[52:55], s12 offen offset:128 nt
  buffer_load_dwordx4 v[92:95], v2, s[52:55], s12 offen offset:256 nt
  buffer_load_dwordx4 v[96:99], v2, s[52:55], s12 offen offset:1536 nt
  buffer_load_dwordx4 v[100:103], v2, s[52:55], s12 offen offset:1664 nt
  buffer_load_dwordx4 v[104:107], v2, s[52:55], s12 offen offset:1792 nt
  v_add_f32_dpp v255, v29, v28 row_ror:8 row_mask:0xf bank_mask:0x3
  v_add_f32_dpp v255, v32, v33 row_ror:8 row_mask:0xf bank_mask:0xc
  v_cvt_pk_bf16_f32 v3, v255, v255
  v_lshlrev_b32 v255, 16, v3
  v_mul_f32 v255, 0x3d93cd3a, v255
  v_cvt_pk_bf16_f32 v3, v255, v255
  v_lshlrev_b32 v255, 16, v3
  ds_write_b32 v253, v255 offset:64
  s_waitcnt vmcnt(42)
  v_mfma_f32_16x16x32_bf16 v[28:31], v[16:19], v[108:111], 0
  v_mfma_f32_16x16x32_bf16 v[32:35], v[16:19], v[120:123], 0
  v_mfma_f32_16x16x32_bf16 v[28:31], v[20:23], v[112:115], v[28:31]
  v_mfma_f32_16x16x32_bf16 v[32:35], v[20:23], v[124:127], v[32:35]
  v_mfma_f32_16x16x32_bf16 v[28:31], v[24:27], v[116:119], v[28:31]
  v_mfma_f32_16x16x32_bf16 v[32:35], v[24:27], v[128:131], v[32:35]
  s_lshr_b32 s8, s7, 6
  s_mul_i32 s8, s8, 393216
  s_and_b32 s9, s7, 63
  s_mul_i32 s10, s9, 3121
  s_lshr_b32 s10, s10, 16
  s_mul_i32 s10, s10, 22
  s_add_u32 s10, s10, s9
  s_cmp_eq_u32 s9, 63
  s_cselect_b32 s10, 42, s10
  s_cselect_b32 s57, 43, 21
  s_mul_i32 s57, s57, 3072
  s_mul_i32 s10, s10, 3072
  s_add_u32 s12, s56, s8
  s_add_u32 s12, s12, s10
  v_mad_u32_u24 v2, v0, s57, v252
  s_add_u32 s7, s7, s80
  s_waitcnt vmcnt(2)
  buffer_load_dwordx4 v[108:111], v2, s[52:55], s12 offen offset:0 nt
  buffer_load_dwordx4 v[112:115], v2, s[52:55], s12 offen offset:128 nt
  buffer_load_dwordx4 v[116:119], v2, s[52:55], s12 offen offset:256 nt
  buffer_load_dwordx4 v[120:123], v2, s[52:55], s12 offen offset:1536 nt
  buffer_load_dwordx4 v[124:127], v2, s[52:55], s12 offen offset:1664 nt
  buffer_load_dwordx4 v[128:131], v2, s[52:55], s12 offen offset:1792 nt
  v_add_f32_dpp v255, v29, v28 row_ror:8 row_mask:0xf bank_mask:0x3
  v_add_f32_dpp v255, v32, v33 row_ror:8 row_mask:0xf bank_mask:0xc
  v_cvt_pk_bf16_f32 v3, v255, v255
  v_lshlrev_b32 v255, 16, v3
  v_mul_f32 v255, 0x3d93cd3a, v255
  v_cvt_pk_bf16_f32 v3, v255, v255
  v_lshlrev_b32 v255, 16, v3
  ds_write_b32 v253, v255 offset:128
  s_waitcnt vmcnt(42)
  v_mfma_f32_16x16x32_bf16 v[28:31], v[16:19], v[132:135], 0
  v_mfma_f32_16x16x32_bf16 v[32:35], v[16:19], v[144:147], 0
  v_mfma_f32_16x16x32_bf16 v[28:31], v[20:23], v[136:139], v[28:31]
  v_mfma_f32_16x16x32_bf16 v[32:35], v[20:23], v[148:151], v[32:35]
  v_mfma_f32_16x16x32_bf16 v[28:31], v[24:27], v[140:143], v[28:31]
  v_mfma_f32_16x16x32_bf16 v[32:35], v[24:27], v[152:155], v[32:35]
  s_lshr_b32 s8, s7, 6
  s_mul_i32 s8, s8, 393216
  s_and_b32 s9, s7, 63
  s_mul_i32 s10, s9, 3121
  s_lshr_b32 s10, s10, 16
  s_mul_i32 s10, s10, 22
  s_add_u32 s10, s10, s9
  s_cmp_eq_u32 s9, 63
  s_cselect_b32 s10, 42, s10
  s_cselect_b32 s57, 43, 21
  s_mul_i32 s57, s57, 3072
  s_mul_i32 s10, s10, 3072
  s_add_u32 s12, s56, s8
  s_add_u32 s12, s12, s10
  v_mad_u32_u24 v2, v0, s57, v252
  s_add_u32 s7, s7, s80
  s_waitcnt vmcnt(2)
  buffer_load_dwordx4 v[132:135], v2, s[52:55], s12 offen offset:0 nt
  buffer_load_dwordx4 v[136:139], v2, s[52:55], s12 offen offset:128 nt
  buffer_load_dwordx4 v[140:143], v2, s[52:55], s12 offen offset:256 nt
  buffer_load_dwordx4 v[144:147], v2, s[52:55], s12 offen offset:1536 nt
  buffer_load_dwordx4 v[148:151], v2, s[52:55], s12 offen offset:1664 nt
  buffer_load_dwordx4 v[152:155], v2, s[52:55], s12 offen offset:1792 nt
  v_add_f32_dpp v255, v29, v28 row_ror:8 row_mask:0xf bank_mask:0x3
  v_add_f32_dpp v255, v32, v33 row_ror:8 row_mask:0xf bank_mask:0xc
  v_cvt_pk_bf16_f32 v3, v255, v255
  v_lshlrev_b32 v255, 16, v3
  v_mul_f32 v255, 0x3d93cd3a, v255
  v_cvt_pk_bf16_f32 v3, v255, v255
  v_lshlrev_b32 v255, 16, v3
  ds_write_b32 v253, v255 offset:192
  s_waitcnt vmcnt(42)
  v_mfma_f32_16x16x32_bf16 v[28:31], v[16:19], v[156:159], 0
  v_mfma_f32_16x16x32_bf16 v[32:35], v[16:19], v[168:171], 0
  v_mfma_f32_16x16x32_bf16 v[28:31], v[20:23], v[160:163], v[28:31]
  v_mfma_f32_16x16x32_bf16 v[32:35], v[20:23], v[172:175], v[32:35]
  v_mfma_f32_16x16x32_bf16 v[28:31], v[24:27], v[164:167], v[28:31]
  v_mfma_f32_16x16x32_bf16 v[32:35], v[24:27], v[176:179], v[32:35]
  s_lshr_b32 s8, s7, 6
  s_mul_i32 s8, s8, 393216
  s_and_b32 s9, s7, 63
  s_mul_i32 s10, s9, 3121
  s_lshr_b32 s10, s10, 16
  s_mul_i32 s10, s10, 22
  s_add_u32 s10, s10, s9
  s_cmp_eq_u32 s9, 63
  s_cselect_b32 s10, 42, s10
  s_cselect_b32 s57, 43, 21
  s_mul_i32 s57, s57, 3072
  s_mul_i32 s10, s10, 3072
  s_add_u32 s12, s56, s8
  s_add_u32 s12, s12, s10
  v_mad_u32_u24 v2, v0, s57, v252
  s_add_u32 s7, s7, s80
  s_waitcnt vmcnt(2)
  buffer_load_dwordx4 v[156:159], v2, s[52:55], s12 offen offset:0 nt
  buffer_load_dwordx4 v[160:163], v2, s[52:55], s12 offen offset:128 nt
  buffer_load_dwordx4 v[164:167], v2, s[52:55], s12 offen offset:256 nt
  buffer_load_dwordx4 v[168:171], v2, s[52:55], s12 offen offset:1536 nt
  buffer_load_dwordx4 v[172:175], v2, s[52:55], s12 offen offset:1664 nt
  buffer_load_dwordx4 v[176:179], v2, s[52:55], s12 offen offset:1792 nt
  v_add_f32_dpp v255, v29, v28 row_ror:8 row_mask:0xf bank_mask:0x3
  v_add_f32_dpp v255, v32, v33 row_ror:8 row_mask:0xf bank_mask:0xc
  v_cvt_pk_bf16_f32 v3, v255, v255
  v_lshlrev_b32 v255, 16, v3
  v_mul_f32 v255, 0x3d93cd3a, v255
  v_cvt_pk_bf16_f32 v3, v255, v255
  v_lshlrev_b32 v255, 16, v3
  ds_write_b32 v253, v255 offset:256
  s_waitcnt vmcnt(42)
  v_mfma_f32_16x16x32_bf16 v[28:31], v[16:19], v[180:183], 0
  v_mfma_f32_16x16x32_bf16 v[32:35], v[16:19], v[192:195], 0
  v_mfma_f32_16x16x32_bf16 v[28:31], v[20:23], v[184:187], v[28:31]
  v_mfma_f32_16x16x32_bf16 v[32:35], v[20:23], v[196:199], v[32:35]
  v_mfma_f32_16x16x32_bf16 v[28:31], v[24:27], v[188:191], v[28:31]
  v_mfma_f32_16x16x32_bf16 v[32:35], v[24:27], v[200:203], v[32:35]
  s_lshr_b32 s8, s7, 6
  s_mul_i32 s8, s8, 393216
  s_and_b32 s9, s7, 63
  s_mul_i32 s10, s9, 3121
  s_lshr_b32 s10, s10, 16
  s_mul_i32 s10, s10, 22
  s_add_u32 s10, s10, s9
  s_cmp_eq_u32 s9, 63
  s_cselect_b32 s10, 42, s10
  s_cselect_b32 s57, 43, 21
  s_mul_i32 s57, s57, 3072
  s_mul_i32 s10, s10, 3072
  s_add_u32 s12, s56, s8
  s_add_u32 s12, s12, s10
  v_mad_u32_u24 v2, v0, s57, v252
  s_add_u32 s7, s7, s80
  s_waitcnt vmcnt(2)
  buffer_load_dwordx4 v[180:183], v2, s[52:55], s12 offen offset:0 nt
  buffer_load_dwordx4 v[184:187], v2, s[52:55], s12 offen offset:128 nt
  buffer_load_dwordx4 v[188:191], v2, s[52:55], s12 offen offset:256 nt
  buffer_load_dwordx4 v[192:195], v2, s[52:55], s12 offen offset:1536 nt
  buffer_load_dwordx4 v[196:199], v2, s[52:55], s12 offen offset:1664 nt
  buffer_load_dwordx4 v[200:203], v2, s[52:55], s12 offen offset:1792 nt
  v_add_f32_dpp v255, v29, v28 row_ror:8 row_mask:0xf bank_mask:0x3
  v_add_f32_dpp v255, v32, v33 row_ror:8 row_mask:0xf bank_mask:0xc
  v_cvt_pk_bf16_f32 v3, v255, v255
  v_lshlrev_b32 v255, 16, v3
  v_mul_f32 v255, 0x3d93cd3a, v255
  v_cvt_pk_bf16_f32 v3, v255, v255
  v_lshlrev_b32 v255, 16, v3
  ds_write_b32 v253, v255 offset:320
  s_waitcnt vmcnt(42)
  v_mfma_f32_16x16x32_bf16 v[28:31], v[16:19], v[204:207], 0
  v_mfma_f32_16x16x32_bf16 v[32:35], v[16:19], v[216:219], 0
  v_mfma_f32_16x16x32_bf16 v[28:31], v[20:23], v[208:211], v[28:31]
  v_mfma_f32_16x16x32_bf16 v[32:35], v[20:23], v[220:223], v[32:35]
  v_mfma_f32_16x16x32_bf16 v[28:31], v[24:27], v[212:215], v[28:31]
  v_mfma_f32_16x16x32_bf16 v[32:35], v[24:27], v[224:227], v[32:35]
  s_lshr_b32 s8, s7, 6
  s_mul_i32 s8, s8, 393216
  s_and_b32 s9, s7, 63
  s_mul_i32 s10, s9, 3121
  s_lshr_b32 s10, s10, 16
  s_mul_i32 s10, s10, 22
  s_add_u32 s10, s10, s9
  s_cmp_eq_u32 s9, 63
  s_cselect_b32 s10, 42, s10
  s_cselect_b32 s57, 43, 21
  s_mul_i32 s57, s57, 3072
  s_mul_i32 s10, s10, 3072
  s_add_u32 s12, s56, s8
  s_add_u32 s12, s12, s10
  v_mad_u32_u24 v2, v0, s57, v252
  s_add_u32 s7, s7, s80
  s_waitcnt vmcnt(2)
  buffer_load_dwordx4 v[204:207], v2, s[52:55], s12 offen offset:0 nt
  buffer_load_dwordx4 v[208:211], v2, s[52:55], s12 offen offset:128 nt
  buffer_load_dwordx4 v[212:215], v2, s[52:55], s12 offen offset:256 nt
  buffer_load_dwordx4 v[216:219], v2, s[52:55], s12 offen offset:1536 nt
  buffer_load_dwordx4 v[220:223], v2, s[52:55], s12 offen offset:1664 nt
  buffer_load_dwordx4 v[224:227], v2, s[52:55], s12 offen offset:1792 nt
  v_add_f32_dpp v255, v29, v28 row_ror:8 row_mask:0xf bank_mask:0x3
  v_add_f32_dpp v255, v32, v33 row_ror:8 row_mask:0xf bank_mask:0xc
  v_cvt_pk_bf16_f32 v3, v255, v255
  v_lshlrev_b32 v255, 16, v3
  v_mul_f32 v255, 0x3d93cd3a, v255
  v_cvt_pk_bf16_f32 v3, v255, v255
  v_lshlrev_b32 v255, 16, v3
  ds_write_b32 v253, v255 offset:384
  s_waitcnt vmcnt(42)
  v_mfma_f32_16x16x32_bf16 v[28:31], v[16:19], v[228:231], 0
  v_mfma_f32_16x16x32_bf16 v[32:35], v[16:19], v[240:243], 0
  v_mfma_f32_16x16x32_bf16 v[28:31], v[20:23], v[232:235], v[28:31]
  v_mfma_f32_16x16x32_bf16 v[32:35], v[20:23], v[244:247], v[32:35]
  v_mfma_f32_16x16x32_bf16 v[28:31], v[24:27], v[236:239], v[28:31]
  v_mfma_f32_16x16x32_bf16 v[32:35], v[24:27], v[248:251], v[32:35]
  s_lshr_b32 s8, s7, 6
  s_mul_i32 s8, s8, 393216
  s_and_b32 s9, s7, 63
  s_mul_i32 s10, s9, 3121
  s_lshr_b32 s10, s10, 16
  s_mul_i32 s10, s10, 22
  s_add_u32 s10, s10, s9
  s_cmp_eq_u32 s9, 63
  s_cselect_b32 s10, 42, s10
  s_cselect_b32 s57, 43, 21
  s_mul_i32 s57, s57, 3072
  s_mul_i32 s10, s10, 3072
  s_add_u32 s12, s56, s8
  s_add_u32 s12, s12, s10
  v_mad_u32_u24 v2, v0, s57, v252
  s_add_u32 s7, s7, s80
  s_waitcnt vmcnt(2)
  buffer_load_dwordx4 v[228:231], v2, s[52:55], s12 offen offset:0 nt
  buffer_load_dwordx4 v[232:235], v2, s[52:55], s12 offen offset:128 nt
  buffer_load_dwordx4 v[236:239], v2, s[52:55], s12 offen offset:256 nt
  buffer_load_dwordx4 v[240:243], v2, s[52:55], s12 offen offset:1536 nt
  buffer_load_dwordx4 v[244:247], v2, s[52:55], s12 offen offset:1664 nt
  buffer_load_dwordx4 v[248:251], v2, s[52:55], s12 offen offset:1792 nt
  v_add_f32_dpp v255, v29, v28 row_ror:8 row_mask:0xf bank_mask:0x3
  v_add_f32_dpp v255, v32, v33 row_ror:8 row_mask:0xf bank_mask:0xc
  v_cvt_pk_bf16_f32 v3, v255, v255
  v_lshlrev_b32 v255, 16, v3
  v_mul_f32 v255, 0x3d93cd3a, v255
  v_cvt_pk_bf16_f32 v3, v255, v255
  v_lshlrev_b32 v255, 16, v3
  ds_write_b32 v253, v255 offset:448
  v_add_u32 v253, 512, v253
  s_add_u32 s59, s59, 1
  s_cmp_lt_u32 s59, 7
  s_cbranch_scc1 L_kloop
L_vloop:
  s_add_u32 s8, s59, 1
  s_cmp_ge_u32 s8, 7
  s_cselect_b32 s52, s48, s44
  s_cselect_b32 s53, s49, s45
  s_cselect_b32 s9, 7, 0
  s_sub_u32 s8, s8, s9
  s_lshr_b32 s9, s8, 1
  s_mul_i32 s56, s9, 100663296
  s_add_u32 s56, s56, s43
  s_and_b32 s8, s8, 1
  s_lshl_b32 s8, s8, 5
  s_add_u32 s7, s58, s8
  ds_read2_b32 v[12:13], v254 offset0:0 offset1:8
  ds_read2_b32 v[14:15], v254 offset0:16 offset1:24
  ds_read2_b32 v[16:17], v254 offset0:32 offset1:40
  ds_read2_b32 v[18:19], v254 offset0:48 offset1:56
  ds_read2_b32 v[20:21], v254 offset0:64 offset1:72
  ds_read2_b32 v[22:23], v254 offset0:80 offset1:88
  ds_read2_b32 v[24:25], v254 offset0:96 offset1:104
  ds_read2_b32 v[26:27], v254 offset0:112 offset1:120
  v_add_u32 v254, 512, v254
  s_waitcnt lgkmcnt(0)
  v_max3_f32 v3, v7, v12, v13
  v_max3_f32 v4, v14, v15, v16
  v_max3_f32 v3, v3, v17, v18
  v_max3_f32 v4, v4, v19, v20
  v_max3_f32 v3, v3, v21, v22
  v_max3_f32 v4, v4, v23, v24
  v_max3_f32 v3, v3, v25, v26
  v_max3_f32 v3, v3, v4, v27
  v_sub_f32 v9, v7, v3
  v_sub_f32 v4, 0, v3
  v_mul_f32 v9, 0x3fb8aa3b, v9
  v_pk_add_f32 v[12:13], v[12:13], v[4:5] op_sel_hi:[1,0]
  v_pk_add_f32 v[14:15], v[14:15], v[4:5] op_sel_hi:[1,0]
  v_pk_add_f32 v[16:17], v[16:17], v[4:5] op_sel_hi:[1,0]
  v_pk_add_f32 v[18:19], v[18:19], v[4:5] op_sel_hi:[1,0]
  v_pk_add_f32 v[20:21], v[20:21], v[4:5] op_sel_hi:[1,0]
  v_pk_add_f32 v[22:23], v[22:23], v[4:5] op_sel_hi:[1,0]
  v_pk_add_f32 v[24:25], v[24:25], v[4:5] op_sel_hi:[1,0]
  v_pk_add_f32 v[26:27], v[26:27], v[4:5] op_sel_hi:[1,0]
  v_exp_f32 v9, v9
  v_pk_mul_f32 v[12:13], v[12:13], s[60:61] op_sel_hi:[1,0]
  v_pk_mul_f32 v[14:15], v[14:15], s[60:61] op_sel_hi:[1,0]
  v_pk_mul_f32 v[16:17], v[16:17], s[60:61] op_sel_hi:[1,0]
  v_pk_mul_f32 v[18:19], v[18:19], s[60:61] op_sel_hi:[1,0]
  v_pk_mul_f32 v[20:21], v[20:21], s[60:61] op_sel_hi:[1,0]
  v_pk_mul_f32 v[22:23], v[22:23], s[60:61] op_sel_hi:[1,0]
  v_pk_mul_f32 v[24:25], v[24:25], s[60:61] op_sel_hi:[1,0]
  v_pk_mul_f32 v[26:27], v[26:27], s[60:61] op_sel_hi:[1,0]
  v_exp_f32 v12, v12
  v_exp_f32 v13, v13
  v_exp_f32 v14, v14
  v_exp_f32 v15, v15
  v_exp_f32 v16, v16
  v_exp_f32 v17, v17
  v_exp_f32 v18, v18
  v_exp_f32 v19, v19
  v_exp_f32 v20, v20
  v_exp_f32 v21, v21
  v_exp_f32 v22, v22
  v_exp_f32 v23, v23
  v_exp_f32 v24, v24
  v_exp_f32 v25, v25
  v_exp_f32 v26, v26
  v_exp_f32 v27, v27
  v_mov_b32 v7, v3
  v_pk_mul_f32 v[36:37], v[36:37], v[8:9] op_sel:[0,1] op_sel_hi:[1,1]
  v_pk_mul_f32 v[38:39], v[38:39], v[8:9] op_sel:[0,1] op_sel_hi:[1,1]
  v_pk_mul_f32 v[40:41], v[40:41], v[8:9] op_sel:[0,1] op_sel_hi:[1,1]
  v_pk_mul_f32 v[42:43], v[42:43], v[8:9] op_sel:[0,1] op_sel_hi:[1,1]
  v_pk_mul_f32 v[44:45], v[44:45], v[8:9] op_sel:[0,1] op_sel_hi:[1,1]
  v_pk_mul_f32 v[46:47], v[46:47], v[8:9] op_sel:[0,1] op_sel_hi:[1,1]
  v_pk_mul_f32 v[48:49], v[48:49], v[8:9] op_sel:[0,1] op_sel_hi:[1,1]
  v_pk_mul_f32 v[50:51], v[50:51], v[8:9] op_sel:[0,1] op_sel_hi:[1,1]
  v_pk_mul_f32 v[52:53], v[52:53], v[8:9] op_sel:[0,1] op_sel_hi:[1,1]
  v_pk_mul_f32 v[54:55], v[54:55], v[8:9] op_sel:[0,1] op_sel_hi:[1,1]
  v_pk_mul_f32 v[56:57], v[56:57], v[8:9] op_sel:[0,1] op_sel_hi:[1,1]
  v_pk_mul_f32 v[58:59], v[58:59], v[8:9] op_sel:[0,1] op_sel_hi:[1,1]
  v_pk_add_f32 v[28:29], v[12:13], v[14:15]
  v_pk_add_f32 v[30:31], v[16:17], v[18:19]
  v_pk_add_f32 v[28:29], v[28:29], v[20:21]
  v_pk_add_f32 v[30:31], v[30:31], v[22:23]
  v_pk_add_f32 v[28:29], v[28:29], v[24:25]
  v_pk_add_f32 v[30:31], v[30:31], v[26:27]
  v_pk_add_f32 v[28:29], v[28:29], v[30:31]
  v_fma_f32 v8, v8, v9, v28
  v_add_f32 v8, v8, v29
  s_waitcnt vmcnt(42)
  v_lshlrev_b32 v28, 16, v60
  v_and_b32 v29, s15, v60
  v_lshlrev_b32 v30, 16, v61
  v_and_b32 v31, s15, v61
  v_lshlrev_b32 v32, 16, v62
  v_and_b32 v33, s15, v62
  v_pk_fma_f32 v[36:37], v[28:29], v[12:13], v[36:37] op_sel_hi:[1,0,1]
  v_lshlrev_b32 v34, 16, v63
  v_and_b32 v35, s15, v63
  v_pk_fma_f32 v[38:39], v[30:31], v[12:13], v[38:39] op_sel_hi:[1,0,1]
  v_lshlrev_b32 v28, 16, v64
  v_and_b32 v29, s15, v64
  v_pk_fma_f32 v[40:41], v[32:33], v[12:13], v[40:41] op_sel_hi:[1,0,1]
  v_lshlrev_b32 v30, 16, v65
  v_and_b32 v31, s15, v65
  v_pk_fma_f32 v[42:43], v[34:35], v[12:13], v[42:43] op_sel_hi:[1,0,1]
  v_lshlrev_b32 v32, 16, v66
  v_and_b32 v33, s15, v66
  v_pk_fma_f32 v[44:45], v[28:29], v[12:13], v[44:45] op_sel_hi:[1,0,1]
  v_lshlrev_b32 v34, 16, v67
  v_and_b32 v35, s15, v67
  v_pk_fma_f32 v[46:47], v[30:31], v[12:13], v[46:47] op_sel_hi:[1,0,1]
  v_lshlrev_b32 v28, 16, v68
  v_and_b32 v29, s15, v68
  v_pk_fma_f32 v[48:49], v[32:33], v[12:13], v[48:49] op_sel_hi:[1,0,1]
  v_lshlrev_b32 v30, 16, v69
  v_and_b32 v31, s15, v69
  v_pk_fma_f32 v[50:51], v[34:35], v[12:13], v[50:51] op_sel_hi:[1,0,1]
  v_lshlrev_b32 v32, 16, v70
  v_and_b32 v33, s15, v70
  v_pk_fma_f32 v[52:53], v[28:29], v[12:13], v[52:53] op_sel_hi:[1,0,1]
  v_lshlrev_b32 v34, 16, v71
  v_and_b32 v35, s15, v71
  v_pk_fma_f32 v[54:55], v[30:31], v[12:13], v[54:55] op_sel_hi:[1,0,1]
  v_lshlrev_b32 v28, 16, v72
  v_and_b32 v29, s15, v72
  v_pk_fma_f32 v[56:57], v[32:33], v[12:13], v[56:57] op_sel_hi:[1,0,1]
  v_lshlrev_b32 v30, 16, v73
  v_and_b32 v31, s15, v73
  v_pk_fma_f32 v[58:59], v[34:35], v[12:13], v[58:59] op_sel_hi:[1,0,1]
  v_lshlrev_b32 v32, 16, v74
  v_and_b32 v33, s15, v74
  v_pk_fma_f32 v[36:37], v[28:29], v[12:13], v[36:37] op_sel:[0,1,0] op_sel_hi:[1,1,1]
  v_lshlrev_b32 v34, 16, v75
  v_and_b32 v35, s15, v75
  v_pk_fma_f32 v[38:39], v[30:31], v[12:13], v[38:39] op_sel:[0,1,0] op_sel_hi:[1,1,1]
  v_lshlrev_b32 v28, 16, v76
  v_and_b32 v29, s15, v76
  v_pk_fma_f32 v[40:41], v[32:33], v[12:13], v[40:41] op_sel:[0,1,0] op_sel_hi:[1,1,1]
  v_lshlrev_b32 v30, 16, v77
  v_and_b32 v31, s15, v77
  v_pk_fma_f32 v[42:43], v[34:35], v[12:13], v[42:43] op_sel:[0,1,0] op_sel_hi:[1,1,1]
  v_lshlrev_b32 v32, 16, v78
  v_and_b32 v33, s15, v78
  v_pk_fma_f32 v[44:45], v[28:29], v[12:13], v[44:45] op_sel:[0,1,0] op_sel_hi:[1,1,1]
  v_lshlrev_b32 v34, 16, v79
  v_and_b32 v35, s15, v79
  v_pk_fma_f32 v[46:47], v[30:31], v[12:13], v[46:47] op_sel:[0,1,0] op_sel_hi:[1,1,1]
  v_lshlrev_b32 v28, 16, v80
  v_and_b32 v29, s15, v80
  v_pk_fma_f32 v[48:49], v[32:33], v[12:13], v[48:49] op_sel:[0,1,0] op_sel_hi:[1,1,1]
  v_lshlrev_b32 v30, 16, v81
  v_and_b32 v31, s15, v81
  v_pk_fma_f32 v[50:51], v[34:35], v[12:13], v[50:51] op_sel:[0,1,0] op_sel_hi:[1,1,1]
  v_lshlrev_b32 v32, 16, v82
  v_and_b32 v33, s15, v82
  v_pk_fma_f32 v[52:53], v[28:29], v[12:13], v[52:53] op_sel:[0,1,0] op_sel_hi:[1,1,1]
  v_lshlrev_b32 v34, 16, v83
  v_and_b32 v35, s15, v83
  v_pk_fma_f32 v[54:55], v[30:31], v[12:13], v[54:55] op_sel:[0,1,0] op_sel_hi:[1,1,1]
  v_pk_fma_f32 v[56:57], v[32:33], v[12:13], v[56:57] op_sel:[0,1,0] op_sel_hi:[1,1,1]
  v_pk_fma_f32 v[58:59], v[34:35], v[12:13], v[58:59] op_sel:[0,1,0] op_sel_hi:[1,1,1]
  s_lshr_b32 s8, s7, 6
  s_mul_i32 s8, s8, 393216
  s_and_b32 s9, s7, 63
  s_mul_i32 s10, s9, 3121
  s_lshr_b32 s10, s10, 16
  s_mul_i32 s10, s10, 22
  s_add_u32 s10, s10, s9
  s_cmp_eq_u32 s9, 63
  s_cselect_b32 s10, 42, s10
  s_cselect_b32 s57, 43, 21
  s_mul_i32 s57, s57, 3072
  s_mul_i32 s10, s10, 3072
  s_add_u32 s12, s56, s8
  s_add_u32 s12, s12, s10
  v_mad_u32_u24 v2, v0, s57, v252
  s_add_u32 s7, s7, s80
  s_waitcnt vmcnt(2)
  buffer_load_dwordx4 v[60:63], v2, s[52:55], s12 offen offset:0 nt
  buffer_load_dwordx4 v[64:67], v2, s[52:55], s12 offen offset:128 nt
  buffer_load_dwordx4 v[68:71], v2, s[52:55], s12 offen offset:256 nt
  buffer_load_dwordx4 v[72:75], v2, s[52:55], s12 offen offset:1536 nt
  buffer_load_dwordx4 v[76:79], v2, s[52:55], s12 offen offset:1664 nt
  buffer_load_dwordx4 v[80:83], v2, s[52:55], s12 offen offset:1792 nt
  s_waitcnt vmcnt(42)
  v_lshlrev_b32 v28, 16, v84
  v_and_b32 v29, s15, v84
  v_lshlrev_b32 v30, 16, v85
  v_and_b32 v31, s15, v85
  v_lshlrev_b32 v32, 16, v86
  v_and_b32 v33, s15, v86
  v_pk_fma_f32 v[36:37], v[28:29], v[14:15], v[36:37] op_sel_hi:[1,0,1]
  v_lshlrev_b32 v34, 16, v87
  v_and_b32 v35, s15, v87
  v_pk_fma_f32 v[38:39], v[30:31], v[14:15], v[38:39] op_sel_hi:[1,0,1]
  v_lshlrev_b32 v28, 16, v88
  v_and_b32 v29, s15, v88
  v_pk_fma_f32 v[40:41], v[32:33], v[14:15], v[40:41] op_sel_hi:[1,0,1]
  v_lshlrev_b32 v30, 16, v89
  v_and_b32 v31, s15, v89
  v_pk_fma_f32 v[42:43], v[34:35], v[14:15], v[42:43] op_sel_hi:[1,0,1]
  v_lshlrev_b32 v32, 16, v90
  v_and_b32 v33, s15, v90
  v_pk_fma_f32 v[44:45], v[28:29], v[14:15], v[44:45] op_sel_hi:[1,0,1]
  v_lshlrev_b32 v34, 16, v91
  v_and_b32 v35, s15, v91
  v_pk_fma_f32 v[46:47], v[30:31], v[14:15], v[46:47] op_sel_hi:[1,0,1]
  v_lshlrev_b32 v28, 16, v92
  v_and_b32 v29, s15, v92
  v_pk_fma_f32 v[48:49], v[32:33], v[14:15], v[48:49] op_sel_hi:[1,0,1]
  v_lshlrev_b32 v30, 16, v93
  v_and_b32 v31, s15, v93
  v_pk_fma_f32 v[50:51], v[34:35], v[14:15], v[50:51] op_sel_hi:[1,0,1]
  v_lshlrev_b32 v32, 16, v94
  v_and_b32 v33, s15, v94
  v_pk_fma_f32 v[52:53], v[28:29], v[14:15], v[52:53] op_sel_hi:[1,0,1]
  v_lshlrev_b32 v34, 16, v95
  v_and_b32 v35, s15, v95
  v_pk_fma_f32 v[54:55], v[30:31], v[14:15], v[54:55] op_sel_hi:[1,0,1]
  v_lshlrev_b32 v28, 16, v96
  v_and_b32 v29, s15, v96
  v_pk_fma_f32 v[56:57], v[32:33], v[14:15], v[56:57] op_sel_hi:[1,0,1]
  v_lshlrev_b32 v30, 16, v97
  v_and_b32 v31, s15, v97
  v_pk_fma_f32 v[58:59], v[34:35], v[14:15], v[58:59] op_sel_hi:[1,0,1]
  v_lshlrev_b32 v32, 16, v98
  v_and_b32 v33, s15, v98
  v_pk_fma_f32 v[36:37], v[28:29], v[14:15], v[36:37] op_sel:[0,1,0] op_sel_hi:[1,1,1]
  v_lshlrev_b32 v34, 16, v99
  v_and_b32 v35, s15, v99
  v_pk_fma_f32 v[38:39], v[30:31], v[14:15], v[38:39] op_sel:[0,1,0] op_sel_hi:[1,1,1]
  v_lshlrev_b32 v28, 16, v100
  v_and_b32 v29, s15, v100
  v_pk_fma_f32 v[40:41], v[32:33], v[14:15], v[40:41] op_sel:[0,1,0] op_sel_hi:[1,1,1]
  v_lshlrev_b32 v30, 16, v101
  v_and_b32 v31, s15, v101
  v_pk_fma_f32 v[42:43], v[34:35], v[14:15], v[42:43] op_sel:[0,1,0] op_sel_hi:[1,1,1]
  v_lshlrev_b32 v32, 16, v102
  v_and_b32 v33, s15, v102
  v_pk_fma_f32 v[44:45], v[28:29], v[14:15], v[44:45] op_sel:[0,1,0] op_sel_hi:[1,1,1]
  v_lshlrev_b32 v34, 16, v103
  v_and_b32 v35, s15, v103
  v_pk_fma_f32 v[46:47], v[30:31], v[14:15], v[46:47] op_sel:[0,1,0] op_sel_hi:[1,1,1]
  v_lshlrev_b32 v28, 16, v104
  v_and_b32 v29, s15, v104
  v_pk_fma_f32 v[48:49], v[32:33], v[14:15], v[48:49] op_sel:[0,1,0] op_sel_hi:[1,1,1]
  v_lshlrev_b32 v30, 16, v105
  v_and_b32 v31, s15, v105
  v_pk_fma_f32 v[50:51], v[34:35], v[14:15], v[50:51] op_sel:[0,1,0] op_sel_hi:[1,1,1]
  v_lshlrev_b32 v32, 16, v106
  v_and_b32 v33, s15, v106
  v_pk_fma_f32 v[52:53], v[28:29], v[14:15], v[52:53] op_sel:[0,1,0] op_sel_hi:[1,1,1]
  v_lshlrev_b32 v34, 16, v107
  v_and_b32 v35, s15, v107
  v_pk_fma_f32 v[54:55], v[30:31], v[14:15], v[54:55] op_sel:[0,1,0] op_sel_hi:[1,1,1]
  v_pk_fma_f32 v[56:57], v[32:33], v[14:15], v[56:57] op_sel:[0,1,0] op_sel_hi:[1,1,1]
  v_pk_fma_f32 v[58:59], v[34:35], v[14:15], v[58:59] op_sel:[0,1,0] op_sel_hi:[1,1,1]
  s_lshr_b32 s8, s7, 6
  s_mul_i32 s8, s8, 393216
  s_and_b32 s9, s7, 63
  s_mul_i32 s10, s9, 3121
  s_lshr_b32 s10, s10, 16
  s_mul_i32 s10, s10, 22
  s_add_u32 s10, s10, s9
  s_cmp_eq_u32 s9, 63
  s_cselect_b32 s10, 42, s10
  s_cselect_b32 s57, 43, 21
  s_mul_i32 s57, s57, 3072
  s_mul_i32 s10, s10, 3072
  s_add_u32 s12, s56, s8
  s_add_u32 s12, s12, s10
  v_mad_u32_u24 v2, v0, s57, v252
  s_add_u32 s7, s7, s80
  s_waitcnt vmcnt(2)
  buffer_load_dwordx4 v[84:87], v2, s[52:55], s12 offen offset:0 nt
  buffer_load_dwordx4 v[88:91], v2, s[52:55], s12 offen offset:128 nt
  buffer_load_dwordx4 v[92:95], v2, s[52:55], s12 offen offset:256 nt
  buffer_load_dwordx4 v[96:99], v2, s[52:55], s12 offen offset:1536 nt
  buffer_load_dwordx4 v[100:103], v2, s[52:55], s12 offen offset:1664 nt
  buffer_load_dwordx4 v[104:107], v2, s[52:55], s12 offen offset:1792 nt
  s_waitcnt vmcnt(42)
  v_lshlrev_b32 v28, 16, v108
  v_and_b32 v29, s15, v108
  v_lshlrev_b32 v30, 16, v109
  v_and_b32 v31, s15, v109
  v_lshlrev_b32 v32, 16, v110
  v_and_b32 v33, s15, v110
  v_pk_fma_f32 v[36:37], v[28:29], v[16:17], v[36:37] op_sel_hi:[1,0,1]
  v_lshlrev_b32 v34, 16, v111
  v_and_b32 v35, s15, v111
  v_pk_fma_f32 v[38:39], v[30:31], v[16:17], v[38:39] op_sel_hi:[1,0,1]
  v_lshlrev_b32 v28, 16, v112
  v_and_b32 v29, s15, v112
  v_pk_fma_f32 v[40:41], v[32:33], v[16:17], v[40:41] op_sel_hi:[1,0,1]
  v_lshlrev_b32 v30, 16, v113
  v_and_b32 v31, s15, v113
  v_pk_fma_f32 v[42:43], v[34:35], v[16:17], v[42:43] op_sel_hi:[1,0,1]
  v_lshlrev_b32 v32, 16, v114
  v_and_b32 v33, s15, v114
  v_pk_fma_f32 v[44:45], v[28:29], v[16:17], v[44:45] op_sel_hi:[1,0,1]
  v_lshlrev_b32 v34, 16, v115
  v_and_b32 v35, s15, v115
  v_pk_fma_f32 v[46:47], v[30:31], v[16:17], v[46:47] op_sel_hi:[1,0,1]
  v_lshlrev_b32 v28, 16, v116
  v_and_b32 v29, s15, v116
  v_pk_fma_f32 v[48:49], v[32:33], v[16:17], v[48:49] op_sel_hi:[1,0,1]
  v_lshlrev_b32 v30, 16, v117
  v_and_b32 v31, s15, v117
  v_pk_fma_f32 v[50:51], v[34:35], v[16:17], v[50:51] op_sel_hi:[1,0,1]
  v_lshlrev_b32 v32, 16, v118
  v_and_b32 v33, s15, v118
  v_pk_fma_f32 v[52:53], v[28:29], v[16:17], v[52:53] op_sel_hi:[1,0,1]
  v_lshlrev_b32 v34, 16, v119
  v_and_b32 v35, s15, v119
  v_pk_fma_f32 v[54:55], v[30:31], v[16:17], v[54:55] op_sel_hi:[1,0,1]
  v_lshlrev_b32 v28, 16, v120
  v_and_b32 v29, s15, v120
  v_pk_fma_f32 v[56:57], v[32:33], v[16:17], v[56:57] op_sel_hi:[1,0,1]
  v_lshlrev_b32 v30, 16, v121
  v_and_b32 v31, s15, v121
  v_pk_fma_f32 v[58:59], v[34:35], v[16:17], v[58:59] op_sel_hi:[1,0,1]
  v_lshlrev_b32 v32, 16, v122
  v_and_b32 v33, s15, v122
  v_pk_fma_f32 v[36:37], v[28:29], v[16:17], v[36:37] op_sel:[0,1,0] op_sel_hi:[1,1,1]
  v_lshlrev_b32 v34, 16, v123
  v_and_b32 v35, s15, v123
  v_pk_fma_f32 v[38:39], v[30:31], v[16:17], v[38:39] op_sel:[0,1,0] op_sel_hi:[1,1,1]
  v_lshlrev_b32 v28, 16, v124
  v_and_b32 v29, s15, v124
  v_pk_fma_f32 v[40:41], v[32:33], v[16:17], v[40:41] op_sel:[0,1,0] op_sel_hi:[1,1,1]
  v_lshlrev_b32 v30, 16, v125
  v_and_b32 v31, s15, v125
  v_pk_fma_f32 v[42:43], v[34:35], v[16:17], v[42:43] op_sel:[0,1,0] op_sel_hi:[1,1,1]
  v_lshlrev_b32 v32, 16, v126
  v_and_b32 v33, s15, v126
  v_pk_fma_f32 v[44:45], v[28:29], v[16:17], v[44:45] op_sel:[0,1,0] op_sel_hi:[1,1,1]
  v_lshlrev_b32 v34, 16, v127
  v_and_b32 v35, s15, v127
  v_pk_fma_f32 v[46:47], v[30:31], v[16:17], v[46:47] op_sel:[0,1,0] op_sel_hi:[1,1,1]
  v_lshlrev_b32 v28, 16, v128
  v_and_b32 v29, s15, v128
  v_pk_fma_f32 v[48:49], v[32:33], v[16:17], v[48:49] op_sel:[0,1,0] op_sel_hi:[1,1,1]
  v_lshlrev_b32 v30, 16, v129
  v_and_b32 v31, s15, v129
  v_pk_fma_f32 v[50:51], v[34:35], v[16:17], v[50:51] op_sel:[0,1,0] op_sel_hi:[1,1,1]
  v_lshlrev_b32 v32, 16, v130
  v_and_b32 v33, s15, v130
  v_pk_fma_f32 v[52:53], v[28:29], v[16:17], v[52:53] op_sel:[0,1,0] op_sel_hi:[1,1,1]
  v_lshlrev_b32 v34, 16, v131
  v_and_b32 v35, s15, v131
  v_pk_fma_f32 v[54:55], v[30:31], v[16:17], v[54:55] op_sel:[0,1,0] op_sel_hi:[1,1,1]
  v_pk_fma_f32 v[56:57], v[32:33], v[16:17], v[56:57] op_sel:[0,1,0] op_sel_hi:[1,1,1]
  v_pk_fma_f32 v[58:59], v[34:35], v[16:17], v[58:59] op_sel:[0,1,0] op_sel_hi:[1,1,1]
  s_lshr_b32 s8, s7, 6
  s_mul_i32 s8, s8, 393216
  s_and_b32 s9, s7, 63
  s_mul_i32 s10, s9, 3121
  s_lshr_b32 s10, s10, 16
  s_mul_i32 s10, s10, 22
  s_add_u32 s10, s10, s9
  s_cmp_eq_u32 s9, 63
  s_cselect_b32 s10, 42, s10
  s_cselect_b32 s57, 43, 21
  s_mul_i32 s57, s57, 3072
  s_mul_i32 s10, s10, 3072
  s_add_u32 s12, s56, s8
  s_add_u32 s12, s12, s10
  v_mad_u32_u24 v2, v0, s57, v252
  s_add_u32 s7, s7, s80
  s_waitcnt vmcnt(2)
  buffer_load_dwordx4 v[108:111], v2, s[52:55], s12 offen offset:0 nt
  buffer_load_dwordx4 v[112:115], v2, s[52:55], s12 offen offset:128 nt
  buffer_load_dwordx4 v[116:119], v2, s[52:55], s12 offen offset:256 nt
  buffer_load_dwordx4 v[120:123], v2, s[52:55], s12 offen offset:1536 nt
  buffer_load_dwordx4 v[124:127], v2, s[52:55], s12 offen offset:1664 nt
  buffer_load_dwordx4 v[128:131], v2, s[52:55], s12 offen offset:1792 nt
  s_waitcnt vmcnt(42)
  v_lshlrev_b32 v28, 16, v132
  v_and_b32 v29, s15, v132
  v_lshlrev_b32 v30, 16, v133
  v_and_b32 v31, s15, v133
  v_lshlrev_b32 v32, 16, v134
  v_and_b32 v33, s15, v134
  v_pk_fma_f32 v[36:37], v[28:29], v[18:19], v[36:37] op_sel_hi:[1,0,1]
  v_lshlrev_b32 v34, 16, v135
  v_and_b32 v35, s15, v135
  v_pk_fma_f32 v[38:39], v[30:31], v[18:19], v[38:39] op_sel_hi:[1,0,1]
  v_lshlrev_b32 v28, 16, v136
  v_and_b32 v29, s15, v136
  v_pk_fma_f32 v[40:41], v[32:33], v[18:19], v[40:41] op_sel_hi:[1,0,1]
  v_lshlrev_b32 v30, 16, v137
  v_and_b32 v31, s15, v137
  v_pk_fma_f32 v[42:43], v[34:35], v[18:19], v[42:43] op_sel_hi:[1,0,1]
  v_lshlrev_b32 v32, 16, v138
  v_and_b32 v33, s15, v138
  v_pk_fma_f32 v[44:45], v[28:29], v[18:19], v[44:45] op_sel_hi:[1,0,1]
  v_lshlrev_b32 v34, 16, v139
  v_and_b32 v35, s15, v139
  v_pk_fma_f32 v[46:47], v[30:31], v[18:19], v[46:47] op_sel_hi:[1,0,1]
  v_lshlrev_b32 v28, 16, v140
  v_and_b32 v29, s15, v140
  v_pk_fma_f32 v[48:49], v[32:33], v[18:19], v[48:49] op_sel_hi:[1,0,1]
  v_lshlrev_b32 v30, 16, v141
  v_and_b32 v31, s15, v141
  v_pk_fma_f32 v[50:51], v[34:35], v[18:19], v[50:51] op_sel_hi:[1,0,1]
  v_lshlrev_b32 v32, 16, v142
  v_and_b32 v33, s15, v142
  v_pk_fma_f32 v[52:53], v[28:29], v[18:19], v[52:53] op_sel_hi:[1,0,1]
  v_lshlrev_b32 v34, 16, v143
  v_and_b32 v35, s15, v143
  v_pk_fma_f32 v[54:55], v[30:31], v[18:19], v[54:55] op_sel_hi:[1,0,1]
  v_lshlrev_b32 v28, 16, v144
  v_and_b32 v29, s15, v144
  v_pk_fma_f32 v[56:57], v[32:33], v[18:19], v[56:57] op_sel_hi:[1,0,1]
  v_lshlrev_b32 v30, 16, v145
  v_and_b32 v31, s15, v145
  v_pk_fma_f32 v[58:59], v[34:35], v[18:19], v[58:59] op_sel_hi:[1,0,1]
  v_lshlrev_b32 v32, 16, v146
  v_and_b32 v33, s15, v146
  v_pk_fma_f32 v[36:37], v[28:29], v[18:19], v[36:37] op_sel:[0,1,0] op_sel_hi:[1,1,1]
  v_lshlrev_b32 v34, 16, v147
  v_and_b32 v35, s15, v147
  v_pk_fma_f32 v[38:39], v[30:31], v[18:19], v[38:39] op_sel:[0,1,0] op_sel_hi:[1,1,1]
  v_lshlrev_b32 v28, 16, v148
  v_and_b32 v29, s15, v148
  v_pk_fma_f32 v[40:41], v[32:33], v[18:19], v[40:41] op_sel:[0,1,0] op_sel_hi:[1,1,1]
  v_lshlrev_b32 v30, 16, v149
  v_and_b32 v31, s15, v149
  v_pk_fma_f32 v[42:43], v[34:35], v[18:19], v[42:43] op_sel:[0,1,0] op_sel_hi:[1,1,1]
  v_lshlrev_b32 v32, 16, v150
  v_and_b32 v33, s15, v150
  v_pk_fma_f32 v[44:45], v[28:29], v[18:19], v[44:45] op_sel:[0,1,0] op_sel_hi:[1,1,1]
  v_lshlrev_b32 v34, 16, v151
  v_and_b32 v35, s15, v151
  v_pk_fma_f32 v[46:47], v[30:31], v[18:19], v[46:47] op_sel:[0,1,0] op_sel_hi:[1,1,1]
  v_lshlrev_b32 v28, 16, v152
  v_and_b32 v29, s15, v152
  v_pk_fma_f32 v[48:49], v[32:33], v[18:19], v[48:49] op_sel:[0,1,0] op_sel_hi:[1,1,1]
  v_lshlrev_b32 v30, 16, v153
  v_and_b32 v31, s15, v153
  v_pk_fma_f32 v[50:51], v[34:35], v[18:19], v[50:51] op_sel:[0,1,0] op_sel_hi:[1,1,1]
  v_lshlrev_b32 v32, 16, v154
  v_and_b32 v33, s15, v154
  v_pk_fma_f32 v[52:53], v[28:29], v[18:19], v[52:53] op_sel:[0,1,0] op_sel_hi:[1,1,1]
  v_lshlrev_b32 v34, 16, v155
  v_and_b32 v35, s15, v155
  v_pk_fma_f32 v[54:55], v[30:31], v[18:19], v[54:55] op_sel:[0,1,0] op_sel_hi:[1,1,1]
  v_pk_fma_f32 v[56:57], v[32:33], v[18:19], v[56:57] op_sel:[0,1,0] op_sel_hi:[1,1,1]
  v_pk_fma_f32 v[58:59], v[34:35], v[18:19], v[58:59] op_sel:[0,1,0] op_sel_hi:[1,1,1]
  s_lshr_b32 s8, s7, 6
  s_mul_i32 s8, s8, 393216
  s_and_b32 s9, s7, 63
  s_mul_i32 s10, s9, 3121
  s_lshr_b32 s10, s10, 16
  s_mul_i32 s10, s10, 22
  s_add_u32 s10, s10, s9
  s_cmp_eq_u32 s9, 63
  s_cselect_b32 s10, 42, s10
  s_cselect_b32 s57, 43, 21
  s_mul_i32 s57, s57, 3072
  s_mul_i32 s10, s10, 3072
  s_add_u32 s12, s56, s8
  s_add_u32 s12, s12, s10
  v_mad_u32_u24 v2, v0, s57, v252
  s_add_u32 s7, s7, s80
  s_waitcnt vmcnt(2)
  buffer_load_dwordx4 v[132:135], v2, s[52:55], s12 offen offset:0 nt
  buffer_load_dwordx4 v[136:139], v2, s[52:55], s12 offen offset:128 nt
  buffer_load_dwordx4 v[140:143], v2, s[52:55], s12 offen offset:256 nt
  buffer_load_dwordx4 v[144:147], v2, s[52:55], s12 offen offset:1536 nt
  buffer_load_dwordx4 v[148:151], v2, s[52:55], s12 offen offset:1664 nt
  buffer_load_dwordx4 v[152:155], v2, s[52:55], s12 offen offset:1792 nt
  s_waitcnt vmcnt(42)
  v_lshlrev_b32 v28, 16, v156
  v_and_b32 v29, s15, v156
  v_lshlrev_b32 v30, 16, v157
  v_and_b32 v31, s15, v157
  v_lshlrev_b32 v32, 16, v158
  v_and_b32 v33, s15, v158
  v_pk_fma_f32 v[36:37], v[28:29], v[20:21], v[36:37] op_sel_hi:[1,0,1]
  v_lshlrev_b32 v34, 16, v159
  v_and_b32 v35, s15, v159
  v_pk_fma_f32 v[38:39], v[30:31], v[20:21], v[38:39] op_sel_hi:[1,0,1]
  v_lshlrev_b32 v28, 16, v160
  v_and_b32 v29, s15, v160
  v_pk_fma_f32 v[40:41], v[32:33], v[20:21], v[40:41] op_sel_hi:[1,0,1]
  v_lshlrev_b32 v30, 16, v161
  v_and_b32 v31, s15, v161
  v_pk_fma_f32 v[42:43], v[34:35], v[20:21], v[42:43] op_sel_hi:[1,0,1]
  v_lshlrev_b32 v32, 16, v162
  v_and_b32 v33, s15, v162
  v_pk_fma_f32 v[44:45], v[28:29], v[20:21], v[44:45] op_sel_hi:[1,0,1]
  v_lshlrev_b32 v34, 16, v163
  v_and_b32 v35, s15, v163
  v_pk_fma_f32 v[46:47], v[30:31], v[20:21], v[46:47] op_sel_hi:[1,0,1]
  v_lshlrev_b32 v28, 16, v164
  v_and_b32 v29, s15, v164
  v_pk_fma_f32 v[48:49], v[32:33], v[20:21], v[48:49] op_sel_hi:[1,0,1]
  v_lshlrev_b32 v30, 16, v165
  v_and_b32 v31, s15, v165
  v_pk_fma_f32 v[50:51], v[34:35], v[20:21], v[50:51] op_sel_hi:[1,0,1]
  v_lshlrev_b32 v32, 16, v166
  v_and_b32 v33, s15, v166
  v_pk_fma_f32 v[52:53], v[28:29], v[20:21], v[52:53] op_sel_hi:[1,0,1]
  v_lshlrev_b32 v34, 16, v167
  v_and_b32 v35, s15, v167
  v_pk_fma_f32 v[54:55], v[30:31], v[20:21], v[54:55] op_sel_hi:[1,0,1]
  v_lshlrev_b32 v28, 16, v168
  v_and_b32 v29, s15, v168
  v_pk_fma_f32 v[56:57], v[32:33], v[20:21], v[56:57] op_sel_hi:[1,0,1]
  v_lshlrev_b32 v30, 16, v169
  v_and_b32 v31, s15, v169
  v_pk_fma_f32 v[58:59], v[34:35], v[20:21], v[58:59] op_sel_hi:[1,0,1]
  v_lshlrev_b32 v32, 16, v170
  v_and_b32 v33, s15, v170
  v_pk_fma_f32 v[36:37], v[28:29], v[20:21], v[36:37] op_sel:[0,1,0] op_sel_hi:[1,1,1]
  v_lshlrev_b32 v34, 16, v171
  v_and_b32 v35, s15, v171
  v_pk_fma_f32 v[38:39], v[30:31], v[20:21], v[38:39] op_sel:[0,1,0] op_sel_hi:[1,1,1]
  v_lshlrev_b32 v28, 16, v172
  v_and_b32 v29, s15, v172
  v_pk_fma_f32 v[40:41], v[32:33], v[20:21], v[40:41] op_sel:[0,1,0] op_sel_hi:[1,1,1]
  v_lshlrev_b32 v30, 16, v173
  v_and_b32 v31, s15, v173
  v_pk_fma_f32 v[42:43], v[34:35], v[20:21], v[42:43] op_sel:[0,1,0] op_sel_hi:[1,1,1]
  v_lshlrev_b32 v32, 16, v174
  v_and_b32 v33, s15, v174
  v_pk_fma_f32 v[44:45], v[28:29], v[20:21], v[44:45] op_sel:[0,1,0] op_sel_hi:[1,1,1]
  v_lshlrev_b32 v34, 16, v175
  v_and_b32 v35, s15, v175
  v_pk_fma_f32 v[46:47], v[30:31], v[20:21], v[46:47] op_sel:[0,1,0] op_sel_hi:[1,1,1]
  v_lshlrev_b32 v28, 16, v176
  v_and_b32 v29, s15, v176
  v_pk_fma_f32 v[48:49], v[32:33], v[20:21], v[48:49] op_sel:[0,1,0] op_sel_hi:[1,1,1]
  v_lshlrev_b32 v30, 16, v177
  v_and_b32 v31, s15, v177
  v_pk_fma_f32 v[50:51], v[34:35], v[20:21], v[50:51] op_sel:[0,1,0] op_sel_hi:[1,1,1]
  v_lshlrev_b32 v32, 16, v178
  v_and_b32 v33, s15, v178
  v_pk_fma_f32 v[52:53], v[28:29], v[20:21], v[52:53] op_sel:[0,1,0] op_sel_hi:[1,1,1]
  v_lshlrev_b32 v34, 16, v179
  v_and_b32 v35, s15, v179
  v_pk_fma_f32 v[54:55], v[30:31], v[20:21], v[54:55] op_sel:[0,1,0] op_sel_hi:[1,1,1]
  v_pk_fma_f32 v[56:57], v[32:33], v[20:21], v[56:57] op_sel:[0,1,0] op_sel_hi:[1,1,1]
  v_pk_fma_f32 v[58:59], v[34:35], v[20:21], v[58:59] op_sel:[0,1,0] op_sel_hi:[1,1,1]
  s_lshr_b32 s8, s7, 6
  s_mul_i32 s8, s8, 393216
  s_and_b32 s9, s7, 63
  s_mul_i32 s10, s9, 3121
  s_lshr_b32 s10, s10, 16
  s_mul_i32 s10, s10, 22
  s_add_u32 s10, s10, s9
  s_cmp_eq_u32 s9, 63
  s_cselect_b32 s10, 42, s10
  s_cselect_b32 s57, 43, 21
  s_mul_i32 s57, s57, 3072
  s_mul_i32 s10, s10, 3072
  s_add_u32 s12, s56, s8
  s_add_u32 s12, s12, s10
  v_mad_u32_u24 v2, v0, s57, v252
  s_add_u32 s7, s7, s80
  s_waitcnt vmcnt(2)
  buffer_load_dwordx4 v[156:159], v2, s[52:55], s12 offen offset:0 nt
  buffer_load_dwordx4 v[160:163], v2, s[52:55], s12 offen offset:128 nt
  buffer_load_dwordx4 v[164:167], v2, s[52:55], s12 offen offset:256 nt
  buffer_load_dwordx4 v[168:171], v2, s[52:55], s12 offen offset:1536 nt
  buffer_load_dwordx4 v[172:175], v2, s[52:55], s12 offen offset:1664 nt
  buffer_load_dwordx4 v[176:179], v2, s[52:55], s12 offen offset:1792 nt
  s_waitcnt vmcnt(42)
  v_lshlrev_b32 v28, 16, v180
  v_and_b32 v29, s15, v180
  v_lshlrev_b32 v30, 16, v181
  v_and_b32 v31, s15, v181
  v_lshlrev_b32 v32, 16, v182
  v_and_b32 v33, s15, v182
  v_pk_fma_f32 v[36:37], v[28:29], v[22:23], v[36:37] op_sel_hi:[1,0,1]
  v_lshlrev_b32 v34, 16, v183
  v_and_b32 v35, s15, v183
  v_pk_fma_f32 v[38:39], v[30:31], v[22:23], v[38:39] op_sel_hi:[1,0,1]
  v_lshlrev_b32 v28, 16, v184
  v_and_b32 v29, s15, v184
  v_pk_fma_f32 v[40:41], v[32:33], v[22:23], v[40:41] op_sel_hi:[1,0,1]
  v_lshlrev_b32 v30, 16, v185
  v_and_b32 v31, s15, v185
  v_pk_fma_f32 v[42:43], v[34:35], v[22:23], v[42:43] op_sel_hi:[1,0,1]
  v_lshlrev_b32 v32, 16, v186
  v_and_b32 v33, s15, v186
  v_pk_fma_f32 v[44:45], v[28:29], v[22:23], v[44:45] op_sel_hi:[1,0,1]
  v_lshlrev_b32 v34, 16, v187
  v_and_b32 v35, s15, v187
  v_pk_fma_f32 v[46:47], v[30:31], v[22:23], v[46:47] op_sel_hi:[1,0,1]
  v_lshlrev_b32 v28, 16, v188
  v_and_b32 v29, s15, v188
  v_pk_fma_f32 v[48:49], v[32:33], v[22:23], v[48:49] op_sel_hi:[1,0,1]
  v_lshlrev_b32 v30, 16, v189
  v_and_b32 v31, s15, v189
  v_pk_fma_f32 v[50:51], v[34:35], v[22:23], v[50:51] op_sel_hi:[1,0,1]
  v_lshlrev_b32 v32, 16, v190
  v_and_b32 v33, s15, v190
  v_pk_fma_f32 v[52:53], v[28:29], v[22:23], v[52:53] op_sel_hi:[1,0,1]
  v_lshlrev_b32 v34, 16, v191
  v_and_b32 v35, s15, v191
  v_pk_fma_f32 v[54:55], v[30:31], v[22:23], v[54:55] op_sel_hi:[1,0,1]
  v_lshlrev_b32 v28, 16, v192
  v_and_b32 v29, s15, v192
  v_pk_fma_f32 v[56:57], v[32:33], v[22:23], v[56:57] op_sel_hi:[1,0,1]
  v_lshlrev_b32 v30, 16, v193
  v_and_b32 v31, s15, v193
  v_pk_fma_f32 v[58:59], v[34:35], v[22:23], v[58:59] op_sel_hi:[1,0,1]
  v_lshlrev_b32 v32, 16, v194
  v_and_b32 v33, s15, v194
  v_pk_fma_f32 v[36:37], v[28:29], v[22:23], v[36:37] op_sel:[0,1,0] op_sel_hi:[1,1,1]
  v_lshlrev_b32 v34, 16, v195
  v_and_b32 v35, s15, v195
  v_pk_fma_f32 v[38:39], v[30:31], v[22:23], v[38:39] op_sel:[0,1,0] op_sel_hi:[1,1,1]
  v_lshlrev_b32 v28, 16, v196
  v_and_b32 v29, s15, v196
  v_pk_fma_f32 v[40:41], v[32:33], v[22:23], v[40:41] op_sel:[0,1,0] op_sel_hi:[1,1,1]
  v_lshlrev_b32 v30, 16, v197
  v_and_b32 v31, s15, v197
  v_pk_fma_f32 v[42:43], v[34:35], v[22:23], v[42:43] op_sel:[0,1,0] op_sel_hi:[1,1,1]
  v_lshlrev_b32 v32, 16, v198
  v_and_b32 v33, s15, v198
  v_pk_fma_f32 v[44:45], v[28:29], v[22:23], v[44:45] op_sel:[0,1,0] op_sel_hi:[1,1,1]
  v_lshlrev_b32 v34, 16, v199
  v_and_b32 v35, s15, v199
  v_pk_fma_f32 v[46:47], v[30:31], v[22:23], v[46:47] op_sel:[0,1,0] op_sel_hi:[1,1,1]
  v_lshlrev_b32 v28, 16, v200
  v_and_b32 v29, s15, v200
  v_pk_fma_f32 v[48:49], v[32:33], v[22:23], v[48:49] op_sel:[0,1,0] op_sel_hi:[1,1,1]
  v_lshlrev_b32 v30, 16, v201
  v_and_b32 v31, s15, v201
  v_pk_fma_f32 v[50:51], v[34:35], v[22:23], v[50:51] op_sel:[0,1,0] op_sel_hi:[1,1,1]
  v_lshlrev_b32 v32, 16, v202
  v_and_b32 v33, s15, v202
  v_pk_fma_f32 v[52:53], v[28:29], v[22:23], v[52:53] op_sel:[0,1,0] op_sel_hi:[1,1,1]
  v_lshlrev_b32 v34, 16, v203
  v_and_b32 v35, s15, v203
  v_pk_fma_f32 v[54:55], v[30:31], v[22:23], v[54:55] op_sel:[0,1,0] op_sel_hi:[1,1,1]
  v_pk_fma_f32 v[56:57], v[32:33], v[22:23], v[56:57] op_sel:[0,1,0] op_sel_hi:[1,1,1]
  v_pk_fma_f32 v[58:59], v[34:35], v[22:23], v[58:59] op_sel:[0,1,0] op_sel_hi:[1,1,1]
  s_lshr_b32 s8, s7, 6
  s_mul_i32 s8, s8, 393216
  s_and_b32 s9, s7, 63
  s_mul_i32 s10, s9, 3121
  s_lshr_b32 s10, s10, 16
  s_mul_i32 s10, s10, 22
  s_add_u32 s10, s10, s9
  s_cmp_eq_u32 s9, 63
  s_cselect_b32 s10, 42, s10
  s_cselect_b32 s57, 43, 21
  s_mul_i32 s57, s57, 3072
  s_mul_i32 s10, s10, 3072
  s_add_u32 s12, s56, s8
  s_add_u32 s12, s12, s10
  v_mad_u32_u24 v2, v0, s57, v252
  s_add_u32 s7, s7, s80
  s_waitcnt vmcnt(2)
  buffer_load_dwordx4 v[180:183], v2, s[52:55], s12 offen offset:0 nt
  buffer_load_dwordx4 v[184:187], v2, s[52:55], s12 offen offset:128 nt
  buffer_load_dwordx4 v[188:191], v2, s[52:55], s12 offen offset:256 nt
  buffer_load_dwordx4 v[192:195], v2, s[52:55], s12 offen offset:1536 nt
  buffer_load_dwordx4 v[196:199], v2, s[52:55], s12 offen offset:1664 nt
  buffer_load_dwordx4 v[200:203], v2, s[52:55], s12 offen offset:1792 nt
  s_waitcnt vmcnt(42)
  v_lshlrev_b32 v28, 16, v204
  v_and_b32 v29, s15, v204
  v_lshlrev_b32 v30, 16, v205
  v_and_b32 v31, s15, v205
  v_lshlrev_b32 v32, 16, v206
  v_and_b32 v33, s15, v206
  v_pk_fma_f32 v[36:37], v[28:29], v[24:25], v[36:37] op_sel_hi:[1,0,1]
  v_lshlrev_b32 v34, 16, v207
  v_and_b32 v35, s15, v207
  v_pk_fma_f32 v[38:39], v[30:31], v[24:25], v[38:39] op_sel_hi:[1,0,1]
  v_lshlrev_b32 v28, 16, v208
  v_and_b32 v29, s15, v208
  v_pk_fma_f32 v[40:41], v[32:33], v[24:25], v[40:41] op_sel_hi:[1,0,1]
  v_lshlrev_b32 v30, 16, v209
  v_and_b32 v31, s15, v209
  v_pk_fma_f32 v[42:43], v[34:35], v[24:25], v[42:43] op_sel_hi:[1,0,1]
  v_lshlrev_b32 v32, 16, v210
  v_and_b32 v33, s15, v210
  v_pk_fma_f32 v[44:45], v[28:29], v[24:25], v[44:45] op_sel_hi:[1,0,1]
  v_lshlrev_b32 v34, 16, v211
  v_and_b32 v35, s15, v211
  v_pk_fma_f32 v[46:47], v[30:31], v[24:25], v[46:47] op_sel_hi:[1,0,1]
  v_lshlrev_b32 v28, 16, v212
  v_and_b32 v29, s15, v212
  v_pk_fma_f32 v[48:49], v[32:33], v[24:25], v[48:49] op_sel_hi:[1,0,1]
  v_lshlrev_b32 v30, 16, v213
  v_and_b32 v31, s15, v213
  v_pk_fma_f32 v[50:51], v[34:35], v[24:25], v[50:51] op_sel_hi:[1,0,1]
  v_lshlrev_b32 v32, 16, v214
  v_and_b32 v33, s15, v214
  v_pk_fma_f32 v[52:53], v[28:29], v[24:25], v[52:53] op_sel_hi:[1,0,1]
  v_lshlrev_b32 v34, 16, v215
  v_and_b32 v35, s15, v215
  v_pk_fma_f32 v[54:55], v[30:31], v[24:25], v[54:55] op_sel_hi:[1,0,1]
  v_lshlrev_b32 v28, 16, v216
  v_and_b32 v29, s15, v216
  v_pk_fma_f32 v[56:57], v[32:33], v[24:25], v[56:57] op_sel_hi:[1,0,1]
  v_lshlrev_b32 v30, 16, v217
  v_and_b32 v31, s15, v217
  v_pk_fma_f32 v[58:59], v[34:35], v[24:25], v[58:59] op_sel_hi:[1,0,1]
  v_lshlrev_b32 v32, 16, v218
  v_and_b32 v33, s15, v218
  v_pk_fma_f32 v[36:37], v[28:29], v[24:25], v[36:37] op_sel:[0,1,0] op_sel_hi:[1,1,1]
  v_lshlrev_b32 v34, 16, v219
  v_and_b32 v35, s15, v219
  v_pk_fma_f32 v[38:39], v[30:31], v[24:25], v[38:39] op_sel:[0,1,0] op_sel_hi:[1,1,1]
  v_lshlrev_b32 v28, 16, v220
  v_and_b32 v29, s15, v220
  v_pk_fma_f32 v[40:41], v[32:33], v[24:25], v[40:41] op_sel:[0,1,0] op_sel_hi:[1,1,1]
  v_lshlrev_b32 v30, 16, v221
  v_and_b32 v31, s15, v221
  v_pk_fma_f32 v[42:43], v[34:35], v[24:25], v[42:43] op_sel:[0,1,0] op_sel_hi:[1,1,1]
  v_lshlrev_b32 v32, 16, v222
  v_and_b32 v33, s15, v222
  v_pk_fma_f32 v[44:45], v[28:29], v[24:25], v[44:45] op_sel:[0,1,0] op_sel_hi:[1,1,1]
  v_lshlrev_b32 v34, 16, v223
  v_and_b32 v35, s15, v223
  v_pk_fma_f32 v[46:47], v[30:31], v[24:25], v[46:47] op_sel:[0,1,0] op_sel_hi:[1,1,1]
  v_lshlrev_b32 v28, 16, v224
  v_and_b32 v29, s15, v224
  v_pk_fma_f32 v[48:49], v[32:33], v[24:25], v[48:49] op_sel:[0,1,0] op_sel_hi:[1,1,1]
  v_lshlrev_b32 v30, 16, v225
  v_and_b32 v31, s15, v225
  v_pk_fma_f32 v[50:51], v[34:35], v[24:25], v[50:51] op_sel:[0,1,0] op_sel_hi:[1,1,1]
  v_lshlrev_b32 v32, 16, v226
  v_and_b32 v33, s15, v226
  v_pk_fma_f32 v[52:53], v[28:29], v[24:25], v[52:53] op_sel:[0,1,0] op_sel_hi:[1,1,1]
  v_lshlrev_b32 v34, 16, v227
  v_and_b32 v35, s15, v227
  v_pk_fma_f32 v[54:55], v[30:31], v[24:25], v[54:55] op_sel:[0,1,0] op_sel_hi:[1,1,1]
  v_pk_fma_f32 v[56:57], v[32:33], v[24:25], v[56:57] op_sel:[0,1,0] op_sel_hi:[1,1,1]
  v_pk_fma_f32 v[58:59], v[34:35], v[24:25], v[58:59] op_sel:[0,1,0] op_sel_hi:[1,1,1]
  s_lshr_b32 s8, s7, 6
  s_mul_i32 s8, s8, 393216
  s_and_b32 s9, s7, 63
  s_mul_i32 s10, s9, 3121
  s_lshr_b32 s10, s10, 16
  s_mul_i32 s10, s10, 22
  s_add_u32 s10, s10, s9
  s_cmp_eq_u32 s9, 63
  s_cselect_b32 s10, 42, s10
  s_cselect_b32 s57, 43, 21
  s_mul_i32 s57, s57, 3072
  s_mul_i32 s10, s10, 3072
  s_add_u32 s12, s56, s8
  s_add_u32 s12, s12, s10
  v_mad_u32_u24 v2, v0, s57, v252
  s_add_u32 s7, s7, s80
  s_waitcnt vmcnt(2)
  buffer_load_dwordx4 v[204:207], v2, s[52:55], s12 offen offset:0 nt
  buffer_load_dwordx4 v[208:211], v2, s[52:55], s12 offen offset:128 nt
  buffer_load_dwordx4 v[212:215], v2, s[52:55], s12 offen offset:256 nt
  buffer_load_dwordx4 v[216:219], v2, s[52:55], s12 offen offset:1536 nt
  buffer_load_dwordx4 v[220:223], v2, s[52:55], s12 offen offset:1664 nt
  buffer_load_dwordx4 v[224:227], v2, s[52:55], s12 offen offset:1792 nt
  s_waitcnt vmcnt(42)
  v_lshlrev_b32 v28, 16, v228
  v_and_b32 v29, s15, v228
  v_lshlrev_b32 v30, 16, v229
  v_and_b32 v31, s15, v229
  v_lshlrev_b32 v32, 16, v230
  v_and_b32 v33, s15, v230
  v_pk_fma_f32 v[36:37], v[28:29], v[26:27], v[36:37] op_sel_hi:[1,0,1]
  v_lshlrev_b32 v34, 16, v231
  v_and_b32 v35, s15, v231
  v_pk_fma_f32 v[38:39], v[30:31], v[26:27], v[38:39] op_sel_hi:[1,0,1]
  v_lshlrev_b32 v28, 16, v232
  v_and_b32 v29, s15, v232
  v_pk_fma_f32 v[40:41], v[32:33], v[26:27], v[40:41] op_sel_hi:[1,0,1]
  v_lshlrev_b32 v30, 16, v233
  v_and_b32 v31, s15, v233
  v_pk_fma_f32 v[42:43], v[34:35], v[26:27], v[42:43] op_sel_hi:[1,0,1]
  v_lshlrev_b32 v32, 16, v234
  v_and_b32 v33, s15, v234
  v_pk_fma_f32 v[44:45], v[28:29], v[26:27], v[44:45] op_sel_hi:[1,0,1]
  v_lshlrev_b32 v34, 16, v235
  v_and_b32 v35, s15, v235
  v_pk_fma_f32 v[46:47], v[30:31], v[26:27], v[46:47] op_sel_hi:[1,0,1]
  v_lshlrev_b32 v28, 16, v236
  v_and_b32 v29, s15, v236
  v_pk_fma_f32 v[48:49], v[32:33], v[26:27], v[48:49] op_sel_hi:[1,0,1]
  v_lshlrev_b32 v30, 16, v237
  v_and_b32 v31, s15, v237
  v_pk_fma_f32 v[50:51], v[34:35], v[26:27], v[50:51] op_sel_hi:[1,0,1]
  v_lshlrev_b32 v32, 16, v238
  v_and_b32 v33, s15, v238
  v_pk_fma_f32 v[52:53], v[28:29], v[26:27], v[52:53] op_sel_hi:[1,0,1]
  v_lshlrev_b32 v34, 16, v239
  v_and_b32 v35, s15, v239
  v_pk_fma_f32 v[54:55], v[30:31], v[26:27], v[54:55] op_sel_hi:[1,0,1]
  v_lshlrev_b32 v28, 16, v240
  v_and_b32 v29, s15, v240
  v_pk_fma_f32 v[56:57], v[32:33], v[26:27], v[56:57] op_sel_hi:[1,0,1]
  v_lshlrev_b32 v30, 16, v241
  v_and_b32 v31, s15, v241
  v_pk_fma_f32 v[58:59], v[34:35], v[26:27], v[58:59] op_sel_hi:[1,0,1]
  v_lshlrev_b32 v32, 16, v242
  v_and_b32 v33, s15, v242
  v_pk_fma_f32 v[36:37], v[28:29], v[26:27], v[36:37] op_sel:[0,1,0] op_sel_hi:[1,1,1]
  v_lshlrev_b32 v34, 16, v243
  v_and_b32 v35, s15, v243
  v_pk_fma_f32 v[38:39], v[30:31], v[26:27], v[38:39] op_sel:[0,1,0] op_sel_hi:[1,1,1]
  v_lshlrev_b32 v28, 16, v244
  v_and_b32 v29, s15, v244
  v_pk_fma_f32 v[40:41], v[32:33], v[26:27], v[40:41] op_sel:[0,1,0] op_sel_hi:[1,1,1]
  v_lshlrev_b32 v30, 16, v245
  v_and_b32 v31, s15, v245
  v_pk_fma_f32 v[42:43], v[34:35], v[26:27], v[42:43] op_sel:[0,1,0] op_sel_hi:[1,1,1]
  v_lshlrev_b32 v32, 16, v246
  v_and_b32 v33, s15, v246
  v_pk_fma_f32 v[44:45], v[28:29], v[26:27], v[44:45] op_sel:[0,1,0] op_sel_hi:[1,1,1]
  v_lshlrev_b32 v34, 16, v247
  v_and_b32 v35, s15, v247
  v_pk_fma_f32 v[46:47], v[30:31], v[26:27], v[46:47] op_sel:[0,1,0] op_sel_hi:[1,1,1]
  v_lshlrev_b32 v28, 16, v248
  v_and_b32 v29, s15, v248
  v_pk_fma_f32 v[48:49], v[32:33], v[26:27], v[48:49] op_sel:[0,1,0] op_sel_hi:[1,1,1]
  v_lshlrev_b32 v30, 16, v249
  v_and_b32 v31, s15, v249
  v_pk_fma_f32 v[50:51], v[34:35], v[26:27], v[50:51] op_sel:[0,1,0] op_sel_hi:[1,1,1]
  v_lshlrev_b32 v32, 16, v250
  v_and_b32 v33, s15, v250
  v_pk_fma_f32 v[52:53], v[28:29], v[26:27], v[52:53] op_sel:[0,1,0] op_sel_hi:[1,1,1]
  v_lshlrev_b32 v34, 16, v251
  v_and_b32 v35, s15, v251
  v_pk_fma_f32 v[54:55], v[30:31], v[26:27], v[54:55] op_sel:[0,1,0] op_sel_hi:[1,1,1]
  v_pk_fma_f32 v[56:57], v[32:33], v[26:27], v[56:57] op_sel:[0,1,0] op_sel_hi:[1,1,1]
  v_pk_fma_f32 v[58:59], v[34:35], v[26:27], v[58:59] op_sel:[0,1,0] op_sel_hi:[1,1,1]
  s_lshr_b32 s8, s7, 6
  s_mul_i32 s8, s8, 393216
  s_and_b32 s9, s7, 63
  s_mul_i32 s10, s9, 3121
  s_lshr_b32 s10, s10, 16
  s_mul_i32 s10, s10, 22
  s_add_u32 s10, s10, s9
  s_cmp_eq_u32 s9, 63
  s_cselect_b32 s10, 42, s10
  s_cselect_b32 s57, 43, 21
  s_mul_i32 s57, s57, 3072
  s_mul_i32 s10, s10, 3072
  s_add_u32 s12, s56, s8
  s_add_u32 s12, s12, s10
  v_mad_u32_u24 v2, v0, s57, v252
  s_add_u32 s7, s7, s80
  s_waitcnt vmcnt(2)
  buffer_load_dwordx4 v[228:231], v2, s[52:55], s12 offen offset:0 nt
  buffer_load_dwordx4 v[232:235], v2, s[52:55], s12 offen offset:128 nt
  buffer_load_dwordx4 v[236:239], v2, s[52:55], s12 offen offset:256 nt
  buffer_load_dwordx4 v[240:243], v2, s[52:55], s12 offen offset:1536 nt
  buffer_load_dwordx4 v[244:247], v2, s[52:55], s12 offen offset:1664 nt
  buffer_load_dwordx4 v[248:251], v2, s[52:55], s12 offen offset:1792 nt
  s_bitcmp1_b32 s59, 0
  s_cbranch_scc1 L_nofl
  s_call_b64 s[92:93], L_flush
  v_mov_b32 v4, 2048
  s_mov_b64 exec, 1
  ds_add_u32 v4, v6 offset:24
  s_mov_b64 exec, -1
  v_mov_b32 v7, 0xff61b1e6
  v_mov_b32 v8, 0
  v_mov_b32 v36, 0
  v_mov_b32 v37, 0
  v_mov_b32 v38, 0
  v_mov_b32 v39, 0
  v_mov_b32 v40, 0
  v_mov_b32 v41, 0
  v_mov_b32 v42, 0
  v_mov_b32 v43, 0
  v_mov_b32 v44, 0
  v_mov_b32 v45, 0
  v_mov_b32 v46, 0
  v_mov_b32 v47, 0
  v_mov_b32 v48, 0
  v_mov_b32 v49, 0
  v_mov_b32 v50, 0
  v_mov_b32 v51, 0
  v_mov_b32 v52, 0
  v_mov_b32 v53, 0
  v_mov_b32 v54, 0
  v_mov_b32 v55, 0
  v_mov_b32 v56, 0
  v_mov_b32 v57, 0
  v_mov_b32 v58, 0
  v_mov_b32 v59, 0
L_nofl:
  s_add_u32 s59, s59, 1
  s_cmp_lt_u32 s59, 13
  s_cbranch_scc1 L_vloop
  ds_read2_b32 v[12:13], v254 offset0:0 offset1:8
  ds_read2_b32 v[14:15], v254 offset0:16 offset1:24
  ds_read2_b32 v[16:17], v254 offset0:32 offset1:40
  ds_read2_b32 v[18:19], v254 offset0:48 offset1:56
  ds_read2_b32 v[20:21], v254 offset0:64 offset1:72
  ds_read2_b32 v[22:23], v254 offset0:80 offset1:88
  ds_read2_b32 v[24:25], v254 offset0:96 offset1:104
  ds_read2_b32 v[26:27], v254 offset0:112 offset1:120
  v_add_u32 v254, 512, v254
  s_waitcnt lgkmcnt(0)
  v_max3_f32 v3, v7, v12, v13
  v_max3_f32 v4, v14, v15, v16
  v_max3_f32 v3, v3, v17, v18
  v_max3_f32 v4, v4, v19, v20
  v_max3_f32 v3, v3, v21, v22
  v_max3_f32 v4, v4, v23, v24
  v_max3_f32 v3, v3, v25, v26
  v_max3_f32 v3, v3, v4, v27
  v_sub_f32 v9, v7, v3
  v_sub_f32 v4, 0, v3
  v_mul_f32 v9, 0x3fb8aa3b, v9
  v_pk_add_f32 v[12:13], v[12:13], v[4:5] op_sel_hi:[1,0]
  v_pk_add_f32 v[14:15], v[14:15], v[4:5] op_sel_hi:[1,0]
  v_pk_add_f32 v[16:17], v[16:17], v[4:5] op_sel_hi:[1,0]
  v_pk_add_f32 v[18:19], v[18:19], v[4:5] op_sel_hi:[1,0]
  v_pk_add_f32 v[20:21], v[20:21], v[4:5] op_sel_hi:[1,0]
  v_pk_add_f32 v[22:23], v[22:23], v[4:5] op_sel_hi:[1,0]
  v_pk_add_f32 v[24:25], v[24:25], v[4:5] op_sel_hi:[1,0]
  v_pk_add_f32 v[26:27], v[26:27], v[4:5] op_sel_hi:[1,0]
  v_exp_f32 v9, v9
  v_pk_mul_f32 v[12:13], v[12:13], s[60:61] op_sel_hi:[1,0]
  v_pk_mul_f32 v[14:15], v[14:15], s[60:61] op_sel_hi:[1,0]
  v_pk_mul_f32 v[16:17], v[16:17], s[60:61] op_sel_hi:[1,0]
  v_pk_mul_f32 v[18:19], v[18:19], s[60:61] op_sel_hi:[1,0]
  v_pk_mul_f32 v[20:21], v[20:21], s[60:61] op_sel_hi:[1,0]
  v_pk_mul_f32 v[22:23], v[22:23], s[60:61] op_sel_hi:[1,0]
  v_pk_mul_f32 v[24:25], v[24:25], s[60:61] op_sel_hi:[1,0]
  v_pk_mul_f32 v[26:27], v[26:27], s[60:61] op_sel_hi:[1,0]
  v_exp_f32 v12, v12
  v_exp_f32 v13, v13
  v_exp_f32 v14, v14
  v_exp_f32 v15, v15
  v_exp_f32 v16, v16
  v_exp_f32 v17, v17
  v_exp_f32 v18, v18
  v_exp_f32 v19, v19
  v_exp_f32 v20, v20
  v_exp_f32 v21, v21
  v_exp_f32 v22, v22
  v_exp_f32 v23, v23
  v_exp_f32 v24, v24
  v_exp_f32 v25, v25
  v_exp_f32 v26, v26
  v_exp_f32 v27, v27
  v_mov_b32 v7, v3
  v_pk_mul_f32 v[36:37], v[36:37], v[8:9] op_sel:[0,1] op_sel_hi:[1,1]
  v_pk_mul_f32 v[38:39], v[38:39], v[8:9] op_sel:[0,1] op_sel_hi:[1,1]
  v_pk_mul_f32 v[40:41], v[40:41], v[8:9] op_sel:[0,1] op_sel_hi:[1,1]
  v_pk_mul_f32 v[42:43], v[42:43], v[8:9] op_sel:[0,1] op_sel_hi:[1,1]
  v_pk_mul_f32 v[44:45], v[44:45], v[8:9] op_sel:[0,1] op_sel_hi:[1,1]
  v_pk_mul_f32 v[46:47], v[46:47], v[8:9] op_sel:[0,1] op_sel_hi:[1,1]
  v_pk_mul_f32 v[48:49], v[48:49], v[8:9] op_sel:[0,1] op_sel_hi:[1,1]
  v_pk_mul_f32 v[50:51], v[50:51], v[8:9] op_sel:[0,1] op_sel_hi:[1,1]
  v_pk_mul_f32 v[52:53], v[52:53], v[8:9] op_sel:[0,1] op_sel_hi:[1,1]
  v_pk_mul_f32 v[54:55], v[54:55], v[8:9] op_sel:[0,1] op_sel_hi:[1,1]
  v_pk_mul_f32 v[56:57], v[56:57], v[8:9] op_sel:[0,1] op_sel_hi:[1,1]
  v_pk_mul_f32 v[58:59], v[58:59], v[8:9] op_sel:[0,1] op_sel_hi:[1,1]
  v_pk_add_f32 v[28:29], v[12:13], v[14:15]
  v_pk_add_f32 v[30:31], v[16:17], v[18:19]
  v_pk_add_f32 v[28:29], v[28:29], v[20:21]
  v_pk_add_f32 v[30:31], v[30:31], v[22:23]
  v_pk_add_f32 v[28:29], v[28:29], v[24:25]
  v_pk_add_f32 v[30:31], v[30:31], v[26:27]
  v_pk_add_f32 v[28:29], v[28:29], v[30:31]
  v_fma_f32 v8, v8, v9, v28
  v_add_f32 v8, v8, v29
  s_mov_b32 s6, 0
  s_waitcnt vmcnt(42)
  v_lshlrev_b32 v28, 16, v60
  v_and_b32 v29, s15, v60
  v_lshlrev_b32 v30, 16, v61
  v_and_b32 v31, s15, v61
  v_lshlrev_b32 v32, 16, v62
  v_and_b32 v33, s15, v62
  v_pk_fma_f32 v[36:37], v[28:29], v[12:13], v[36:37] op_sel_hi:[1,0,1]
  v_lshlrev_b32 v34, 16, v63
  v_and_b32 v35, s15, v63
  v_pk_fma_f32 v[38:39], v[30:31], v[12:13], v[38:39] op_sel_hi:[1,0,1]
  v_lshlrev_b32 v28, 16, v64
  v_and_b32 v29, s15, v64
  v_pk_fma_f32 v[40:41], v[32:33], v[12:13], v[40:41] op_sel_hi:[1,0,1]
  v_lshlrev_b32 v30, 16, v65
  v_and_b32 v31, s15, v65
  v_pk_fma_f32 v[42:43], v[34:35], v[12:13], v[42:43] op_sel_hi:[1,0,1]
  v_lshlrev_b32 v32, 16, v66
  v_and_b32 v33, s15, v66
  v_pk_fma_f32 v[44:45], v[28:29], v[12:13], v[44:45] op_sel_hi:[1,0,1]
  v_lshlrev_b32 v34, 16, v67
  v_and_b32 v35, s15, v67
  v_pk_fma_f32 v[46:47], v[30:31], v[12:13], v[46:47] op_sel_hi:[1,0,1]
  v_lshlrev_b32 v28, 16, v68
  v_and_b32 v29, s15, v68
  v_pk_fma_f32 v[48:49], v[32:33], v[12:13], v[48:49] op_sel_hi:[1,0,1]
  v_lshlrev_b32 v30, 16, v69
  v_and_b32 v31, s15, v69
  v_pk_fma_f32 v[50:51], v[34:35], v[12:13], v[50:51] op_sel_hi:[1,0,1]
  v_lshlrev_b32 v32, 16, v70
  v_and_b32 v33, s15, v70
  v_pk_fma_f32 v[52:53], v[28:29], v[12:13], v[52:53] op_sel_hi:[1,0,1]
  v_lshlrev_b32 v34, 16, v71
  v_and_b32 v35, s15, v71
  v_pk_fma_f32 v[54:55], v[30:31], v[12:13], v[54:55] op_sel_hi:[1,0,1]
  v_lshlrev_b32 v28, 16, v72
  v_and_b32 v29, s15, v72
  v_pk_fma_f32 v[56:57], v[32:33], v[12:13], v[56:57] op_sel_hi:[1,0,1]
  v_lshlrev_b32 v30, 16, v73
  v_and_b32 v31, s15, v73
  v_pk_fma_f32 v[58:59], v[34:35], v[12:13], v[58:59] op_sel_hi:[1,0,1]
  v_lshlrev_b32 v32, 16, v74
  v_and_b32 v33, s15, v74
  v_pk_fma_f32 v[36:37], v[28:29], v[12:13], v[36:37] op_sel:[0,1,0] op_sel_hi:[1,1,1]
  v_lshlrev_b32 v34, 16, v75
  v_and_b32 v35, s15, v75
  v_pk_fma_f32 v[38:39], v[30:31], v[12:13], v[38:39] op_sel:[0,1,0] op_sel_hi:[1,1,1]
  v_lshlrev_b32 v28, 16, v76
  v_and_b32 v29, s15, v76
  v_pk_fma_f32 v[40:41], v[32:33], v[12:13], v[40:41] op_sel:[0,1,0] op_sel_hi:[1,1,1]
  v_lshlrev_b32 v30, 16, v77
  v_and_b32 v31, s15, v77
  v_pk_fma_f32 v[42:43], v[34:35], v[12:13], v[42:43] op_sel:[0,1,0] op_sel_hi:[1,1,1]
  v_lshlrev_b32 v32, 16, v78
  v_and_b32 v33, s15, v78
  v_pk_fma_f32 v[44:45], v[28:29], v[12:13], v[44:45] op_sel:[0,1,0] op_sel_hi:[1,1,1]
  v_lshlrev_b32 v34, 16, v79
  v_and_b32 v35, s15, v79
  v_pk_fma_f32 v[46:47], v[30:31], v[12:13], v[46:47] op_sel:[0,1,0] op_sel_hi:[1,1,1]
  v_lshlrev_b32 v28, 16, v80
  v_and_b32 v29, s15, v80
  v_pk_fma_f32 v[48:49], v[32:33], v[12:13], v[48:49] op_sel:[0,1,0] op_sel_hi:[1,1,1]
  v_lshlrev_b32 v30, 16, v81
  v_and_b32 v31, s15, v81
  v_pk_fma_f32 v[50:51], v[34:35], v[12:13], v[50:51] op_sel:[0,1,0] op_sel_hi:[1,1,1]
  v_lshlrev_b32 v32, 16, v82
  v_and_b32 v33, s15, v82
  v_pk_fma_f32 v[52:53], v[28:29], v[12:13], v[52:53] op_sel:[0,1,0] op_sel_hi:[1,1,1]
  v_lshlrev_b32 v34, 16, v83
  v_and_b32 v35, s15, v83
  v_pk_fma_f32 v[54:55], v[30:31], v[12:13], v[54:55] op_sel:[0,1,0] op_sel_hi:[1,1,1]
  v_pk_fma_f32 v[56:57], v[32:33], v[12:13], v[56:57] op_sel:[0,1,0] op_sel_hi:[1,1,1]
  v_pk_fma_f32 v[58:59], v[34:35], v[12:13], v[58:59] op_sel:[0,1,0] op_sel_hi:[1,1,1]
  s_lshl_b64 exec, 1, s82
  global_atomic_add v5, v11, v6, s[40:41] sc0
  s_mov_b64 exec, -1
  s_add_u32 s82, s82, 1
  s_lshr_b32 s8, s7, 6
  s_mul_i32 s8, s8, 393216
  s_and_b32 s9, s7, 63
  s_mul_i32 s10, s9, 3121
  s_lshr_b32 s10, s10, 16
  s_mul_i32 s10, s10, 22
  s_add_u32 s10, s10, s9
  s_cmp_eq_u32 s9, 63
  s_cselect_b32 s10, 42, s10
  s_cselect_b32 s57, 43, 21
  s_mul_i32 s57, s57, 3072
  s_mul_i32 s10, s10, 3072
  s_add_u32 s12, s56, s8
  s_add_u32 s12, s12, s10
  v_mad_u32_u24 v2, v0, s57, v252
  s_add_u32 s7, s7, s80
  buffer_load_dwordx4 v[60:63], v2, s[44:47], s12 offen offset:0 nt
  buffer_load_dwordx4 v[64:67], v2, s[44:47], s12 offen offset:128 nt
  buffer_load_dwordx4 v[68:71], v2, s[44:47], s12 offen offset:256 nt
  buffer_load_dwordx4 v[72:75], v2, s[44:47], s12 offen offset:1536 nt
  buffer_load_dwordx4 v[76:79], v2, s[44:47], s12 offen offset:1664 nt
  buffer_load_dwordx4 v[80:83], v2, s[44:47], s12 offen offset:1792 nt
  s_waitcnt vmcnt(42)
  v_lshlrev_b32 v28, 16, v84
  v_and_b32 v29, s15, v84
  v_lshlrev_b32 v30, 16, v85
  v_and_b32 v31, s15, v85
  v_lshlrev_b32 v32, 16, v86
  v_and_b32 v33, s15, v86
  v_pk_fma_f32 v[36:37], v[28:29], v[14:15], v[36:37] op_sel_hi:[1,0,1]
  v_lshlrev_b32 v34, 16, v87
  v_and_b32 v35, s15, v87
  v_pk_fma_f32 v[38:39], v[30:31], v[14:15], v[38:39] op_sel_hi:[1,0,1]
  v_lshlrev_b32 v28, 16, v88
  v_and_b32 v29, s15, v88
  v_pk_fma_f32 v[40:41], v[32:33], v[14:15], v[40:41] op_sel_hi:[1,0,1]
  v_lshlrev_b32 v30, 16, v89
  v_and_b32 v31, s15, v89
  v_pk_fma_f32 v[42:43], v[34:35], v[14:15], v[42:43] op_sel_hi:[1,0,1]
  v_lshlrev_b32 v32, 16, v90
  v_and_b32 v33, s15, v90
  v_pk_fma_f32 v[44:45], v[28:29], v[14:15], v[44:45] op_sel_hi:[1,0,1]
  v_lshlrev_b32 v34, 16, v91
  v_and_b32 v35, s15, v91
  v_pk_fma_f32 v[46:47], v[30:31], v[14:15], v[46:47] op_sel_hi:[1,0,1]
  v_lshlrev_b32 v28, 16, v92
  v_and_b32 v29, s15, v92
  v_pk_fma_f32 v[48:49], v[32:33], v[14:15], v[48:49] op_sel_hi:[1,0,1]
  v_lshlrev_b32 v30, 16, v93
  v_and_b32 v31, s15, v93
  v_pk_fma_f32 v[50:51], v[34:35], v[14:15], v[50:51] op_sel_hi:[1,0,1]
  v_lshlrev_b32 v32, 16, v94
  v_and_b32 v33, s15, v94
  v_pk_fma_f32 v[52:53], v[28:29], v[14:15], v[52:53] op_sel_hi:[1,0,1]
  v_lshlrev_b32 v34, 16, v95
  v_and_b32 v35, s15, v95
  v_pk_fma_f32 v[54:55], v[30:31], v[14:15], v[54:55] op_sel_hi:[1,0,1]
  v_lshlrev_b32 v28, 16, v96
  v_and_b32 v29, s15, v96
  v_pk_fma_f32 v[56:57], v[32:33], v[14:15], v[56:57] op_sel_hi:[1,0,1]
  v_lshlrev_b32 v30, 16, v97
  v_and_b32 v31, s15, v97
  v_pk_fma_f32 v[58:59], v[34:35], v[14:15], v[58:59] op_sel_hi:[1,0,1]
  v_lshlrev_b32 v32, 16, v98
  v_and_b32 v33, s15, v98
  v_pk_fma_f32 v[36:37], v[28:29], v[14:15], v[36:37] op_sel:[0,1,0] op_sel_hi:[1,1,1]
  v_lshlrev_b32 v34, 16, v99
  v_and_b32 v35, s15, v99
  v_pk_fma_f32 v[38:39], v[30:31], v[14:15], v[38:39] op_sel:[0,1,0] op_sel_hi:[1,1,1]
  v_lshlrev_b32 v28, 16, v100
  v_and_b32 v29, s15, v100
  v_pk_fma_f32 v[40:41], v[32:33], v[14:15], v[40:41] op_sel:[0,1,0] op_sel_hi:[1,1,1]
  v_lshlrev_b32 v30, 16, v101
  v_and_b32 v31, s15, v101
  v_pk_fma_f32 v[42:43], v[34:35], v[14:15], v[42:43] op_sel:[0,1,0] op_sel_hi:[1,1,1]
  v_lshlrev_b32 v32, 16, v102
  v_and_b32 v33, s15, v102
  v_pk_fma_f32 v[44:45], v[28:29], v[14:15], v[44:45] op_sel:[0,1,0] op_sel_hi:[1,1,1]
  v_lshlrev_b32 v34, 16, v103
  v_and_b32 v35, s15, v103
  v_pk_fma_f32 v[46:47], v[30:31], v[14:15], v[46:47] op_sel:[0,1,0] op_sel_hi:[1,1,1]
  v_lshlrev_b32 v28, 16, v104
  v_and_b32 v29, s15, v104
  v_pk_fma_f32 v[48:49], v[32:33], v[14:15], v[48:49] op_sel:[0,1,0] op_sel_hi:[1,1,1]
  v_lshlrev_b32 v30, 16, v105
  v_and_b32 v31, s15, v105
  v_pk_fma_f32 v[50:51], v[34:35], v[14:15], v[50:51] op_sel:[0,1,0] op_sel_hi:[1,1,1]
  v_lshlrev_b32 v32, 16, v106
  v_and_b32 v33, s15, v106
  v_pk_fma_f32 v[52:53], v[28:29], v[14:15], v[52:53] op_sel:[0,1,0] op_sel_hi:[1,1,1]
  v_lshlrev_b32 v34, 16, v107
  v_and_b32 v35, s15, v107
  v_pk_fma_f32 v[54:55], v[30:31], v[14:15], v[54:55] op_sel:[0,1,0] op_sel_hi:[1,1,1]
  v_pk_fma_f32 v[56:57], v[32:33], v[14:15], v[56:57] op_sel:[0,1,0] op_sel_hi:[1,1,1]
  v_pk_fma_f32 v[58:59], v[34:35], v[14:15], v[58:59] op_sel:[0,1,0] op_sel_hi:[1,1,1]
  buffer_load_dwordx4 v[84:87], v2, s[48:51], s12 offen offset:0 nt
  buffer_load_dwordx4 v[88:91], v2, s[48:51], s12 offen offset:128 nt
  buffer_load_dwordx4 v[92:95], v2, s[48:51], s12 offen offset:256 nt
  buffer_load_dwordx4 v[96:99], v2, s[48:51], s12 offen offset:1536 nt
  buffer_load_dwordx4 v[100:103], v2, s[48:51], s12 offen offset:1664 nt
  buffer_load_dwordx4 v[104:107], v2, s[48:51], s12 offen offset:1792 nt
  s_waitcnt vmcnt(42)
  v_lshlrev_b32 v28, 16, v108
  v_and_b32 v29, s15, v108
  v_lshlrev_b32 v30, 16, v109
  v_and_b32 v31, s15, v109
  v_lshlrev_b32 v32, 16, v110
  v_and_b32 v33, s15, v110
  v_pk_fma_f32 v[36:37], v[28:29], v[16:17], v[36:37] op_sel_hi:[1,0,1]
  v_lshlrev_b32 v34, 16, v111
  v_and_b32 v35, s15, v111
  v_pk_fma_f32 v[38:39], v[30:31], v[16:17], v[38:39] op_sel_hi:[1,0,1]
  v_lshlrev_b32 v28, 16, v112
  v_and_b32 v29, s15, v112
  v_pk_fma_f32 v[40:41], v[32:33], v[16:17], v[40:41] op_sel_hi:[1,0,1]
  v_lshlrev_b32 v30, 16, v113
  v_and_b32 v31, s15, v113
  v_pk_fma_f32 v[42:43], v[34:35], v[16:17], v[42:43] op_sel_hi:[1,0,1]
  v_lshlrev_b32 v32, 16, v114
  v_and_b32 v33, s15, v114
  v_pk_fma_f32 v[44:45], v[28:29], v[16:17], v[44:45] op_sel_hi:[1,0,1]
  v_lshlrev_b32 v34, 16, v115
  v_and_b32 v35, s15, v115
  v_pk_fma_f32 v[46:47], v[30:31], v[16:17], v[46:47] op_sel_hi:[1,0,1]
  v_lshlrev_b32 v28, 16, v116
  v_and_b32 v29, s15, v116
  v_pk_fma_f32 v[48:49], v[32:33], v[16:17], v[48:49] op_sel_hi:[1,0,1]
  v_lshlrev_b32 v30, 16, v117
  v_and_b32 v31, s15, v117
  v_pk_fma_f32 v[50:51], v[34:35], v[16:17], v[50:51] op_sel_hi:[1,0,1]
  v_lshlrev_b32 v32, 16, v118
  v_and_b32 v33, s15, v118
  v_pk_fma_f32 v[52:53], v[28:29], v[16:17], v[52:53] op_sel_hi:[1,0,1]
  v_lshlrev_b32 v34, 16, v119
  v_and_b32 v35, s15, v119
  v_pk_fma_f32 v[54:55], v[30:31], v[16:17], v[54:55] op_sel_hi:[1,0,1]
  v_lshlrev_b32 v28, 16, v120
  v_and_b32 v29, s15, v120
  v_pk_fma_f32 v[56:57], v[32:33], v[16:17], v[56:57] op_sel_hi:[1,0,1]
  v_lshlrev_b32 v30, 16, v121
  v_and_b32 v31, s15, v121
  v_pk_fma_f32 v[58:59], v[34:35], v[16:17], v[58:59] op_sel_hi:[1,0,1]
  v_lshlrev_b32 v32, 16, v122
  v_and_b32 v33, s15, v122
  v_pk_fma_f32 v[36:37], v[28:29], v[16:17], v[36:37] op_sel:[0,1,0] op_sel_hi:[1,1,1]
  v_lshlrev_b32 v34, 16, v123
  v_and_b32 v35, s15, v123
  v_pk_fma_f32 v[38:39], v[30:31], v[16:17], v[38:39] op_sel:[0,1,0] op_sel_hi:[1,1,1]
  v_lshlrev_b32 v28, 16, v124
  v_and_b32 v29, s15, v124
  v_pk_fma_f32 v[40:41], v[32:33], v[16:17], v[40:41] op_sel:[0,1,0] op_sel_hi:[1,1,1]
  v_lshlrev_b32 v30, 16, v125
  v_and_b32 v31, s15, v125
  v_pk_fma_f32 v[42:43], v[34:35], v[16:17], v[42:43] op_sel:[0,1,0] op_sel_hi:[1,1,1]
  v_lshlrev_b32 v32, 16, v126
  v_and_b32 v33, s15, v126
  v_pk_fma_f32 v[44:45], v[28:29], v[16:17], v[44:45] op_sel:[0,1,0] op_sel_hi:[1,1,1]
  v_lshlrev_b32 v34, 16, v127
  v_and_b32 v35, s15, v127
  v_pk_fma_f32 v[46:47], v[30:31], v[16:17], v[46:47] op_sel:[0,1,0] op_sel_hi:[1,1,1]
  v_lshlrev_b32 v28, 16, v128
  v_and_b32 v29, s15, v128
  v_pk_fma_f32 v[48:49], v[32:33], v[16:17], v[48:49] op_sel:[0,1,0] op_sel_hi:[1,1,1]
  v_lshlrev_b32 v30, 16, v129
  v_and_b32 v31, s15, v129
  v_pk_fma_f32 v[50:51], v[34:35], v[16:17], v[50:51] op_sel:[0,1,0] op_sel_hi:[1,1,1]
  v_lshlrev_b32 v32, 16, v130
  v_and_b32 v33, s15, v130
  v_pk_fma_f32 v[52:53], v[28:29], v[16:17], v[52:53] op_sel:[0,1,0] op_sel_hi:[1,1,1]
  v_lshlrev_b32 v34, 16, v131
  v_and_b32 v35, s15, v131
  v_pk_fma_f32 v[54:55], v[30:31], v[16:17], v[54:55] op_sel:[0,1,0] op_sel_hi:[1,1,1]
  v_pk_fma_f32 v[56:57], v[32:33], v[16:17], v[56:57] op_sel:[0,1,0] op_sel_hi:[1,1,1]
  v_pk_fma_f32 v[58:59], v[34:35], v[16:17], v[58:59] op_sel:[0,1,0] op_sel_hi:[1,1,1]
  s_lshr_b32 s8, s7, 6
  s_mul_i32 s8, s8, 393216
  s_and_b32 s9, s7, 63
  s_mul_i32 s10, s9, 3121
  s_lshr_b32 s10, s10, 16
  s_mul_i32 s10, s10, 22
  s_add_u32 s10, s10, s9
  s_cmp_eq_u32 s9, 63
  s_cselect_b32 s10, 42, s10
  s_cselect_b32 s57, 43, 21
  s_mul_i32 s57, s57, 3072
  s_mul_i32 s10, s10, 3072
  s_add_u32 s12, s56, s8
  s_add_u32 s12, s12, s10
  v_mad_u32_u24 v2, v0, s57, v252
  s_add_u32 s7, s7, s80
  buffer_load_dwordx4 v[108:111], v2, s[44:47], s12 offen offset:0 nt
  buffer_load_dwordx4 v[112:115], v2, s[44:47], s12 offen offset:128 nt
  buffer_load_dwordx4 v[116:119], v2, s[44:47], s12 offen offset:256 nt
  buffer_load_dwordx4 v[120:123], v2, s[44:47], s12 offen offset:1536 nt
  buffer_load_dwordx4 v[124:127], v2, s[44:47], s12 offen offset:1664 nt
  buffer_load_dwordx4 v[128:131], v2, s[44:47], s12 offen offset:1792 nt
  s_waitcnt vmcnt(42)
  v_lshlrev_b32 v28, 16, v132
  v_and_b32 v29, s15, v132
  v_lshlrev_b32 v30, 16, v133
  v_and_b32 v31, s15, v133
  v_lshlrev_b32 v32, 16, v134
  v_and_b32 v33, s15, v134
  v_pk_fma_f32 v[36:37], v[28:29], v[18:19], v[36:37] op_sel_hi:[1,0,1]
  v_lshlrev_b32 v34, 16, v135
  v_and_b32 v35, s15, v135
  v_pk_fma_f32 v[38:39], v[30:31], v[18:19], v[38:39] op_sel_hi:[1,0,1]
  v_lshlrev_b32 v28, 16, v136
  v_and_b32 v29, s15, v136
  v_pk_fma_f32 v[40:41], v[32:33], v[18:19], v[40:41] op_sel_hi:[1,0,1]
  v_lshlrev_b32 v30, 16, v137
  v_and_b32 v31, s15, v137
  v_pk_fma_f32 v[42:43], v[34:35], v[18:19], v[42:43] op_sel_hi:[1,0,1]
  v_lshlrev_b32 v32, 16, v138
  v_and_b32 v33, s15, v138
  v_pk_fma_f32 v[44:45], v[28:29], v[18:19], v[44:45] op_sel_hi:[1,0,1]
  v_lshlrev_b32 v34, 16, v139
  v_and_b32 v35, s15, v139
  v_pk_fma_f32 v[46:47], v[30:31], v[18:19], v[46:47] op_sel_hi:[1,0,1]
  v_lshlrev_b32 v28, 16, v140
  v_and_b32 v29, s15, v140
  v_pk_fma_f32 v[48:49], v[32:33], v[18:19], v[48:49] op_sel_hi:[1,0,1]
  v_lshlrev_b32 v30, 16, v141
  v_and_b32 v31, s15, v141
  v_pk_fma_f32 v[50:51], v[34:35], v[18:19], v[50:51] op_sel_hi:[1,0,1]
  v_lshlrev_b32 v32, 16, v142
  v_and_b32 v33, s15, v142
  v_pk_fma_f32 v[52:53], v[28:29], v[18:19], v[52:53] op_sel_hi:[1,0,1]
  v_lshlrev_b32 v34, 16, v143
  v_and_b32 v35, s15, v143
  v_pk_fma_f32 v[54:55], v[30:31], v[18:19], v[54:55] op_sel_hi:[1,0,1]
  v_lshlrev_b32 v28, 16, v144
  v_and_b32 v29, s15, v144
  v_pk_fma_f32 v[56:57], v[32:33], v[18:19], v[56:57] op_sel_hi:[1,0,1]
  v_lshlrev_b32 v30, 16, v145
  v_and_b32 v31, s15, v145
  v_pk_fma_f32 v[58:59], v[34:35], v[18:19], v[58:59] op_sel_hi:[1,0,1]
  v_lshlrev_b32 v32, 16, v146
  v_and_b32 v33, s15, v146
  v_pk_fma_f32 v[36:37], v[28:29], v[18:19], v[36:37] op_sel:[0,1,0] op_sel_hi:[1,1,1]
  v_lshlrev_b32 v34, 16, v147
  v_and_b32 v35, s15, v147
  v_pk_fma_f32 v[38:39], v[30:31], v[18:19], v[38:39] op_sel:[0,1,0] op_sel_hi:[1,1,1]
  v_lshlrev_b32 v28, 16, v148
  v_and_b32 v29, s15, v148
  v_pk_fma_f32 v[40:41], v[32:33], v[18:19], v[40:41] op_sel:[0,1,0] op_sel_hi:[1,1,1]
  v_lshlrev_b32 v30, 16, v149
  v_and_b32 v31, s15, v149
  v_pk_fma_f32 v[42:43], v[34:35], v[18:19], v[42:43] op_sel:[0,1,0] op_sel_hi:[1,1,1]
  v_lshlrev_b32 v32, 16, v150
  v_and_b32 v33, s15, v150
  v_pk_fma_f32 v[44:45], v[28:29], v[18:19], v[44:45] op_sel:[0,1,0] op_sel_hi:[1,1,1]
  v_lshlrev_b32 v34, 16, v151
  v_and_b32 v35, s15, v151
  v_pk_fma_f32 v[46:47], v[30:31], v[18:19], v[46:47] op_sel:[0,1,0] op_sel_hi:[1,1,1]
  v_lshlrev_b32 v28, 16, v152
  v_and_b32 v29, s15, v152
  v_pk_fma_f32 v[48:49], v[32:33], v[18:19], v[48:49] op_sel:[0,1,0] op_sel_hi:[1,1,1]
  v_lshlrev_b32 v30, 16, v153
  v_and_b32 v31, s15, v153
  v_pk_fma_f32 v[50:51], v[34:35], v[18:19], v[50:51] op_sel:[0,1,0] op_sel_hi:[1,1,1]
  v_lshlrev_b32 v32, 16, v154
  v_and_b32 v33, s15, v154
  v_pk_fma_f32 v[52:53], v[28:29], v[18:19], v[52:53] op_sel:[0,1,0] op_sel_hi:[1,1,1]
  v_lshlrev_b32 v34, 16, v155
  v_and_b32 v35, s15, v155
  v_pk_fma_f32 v[54:55], v[30:31], v[18:19], v[54:55] op_sel:[0,1,0] op_sel_hi:[1,1,1]
  v_pk_fma_f32 v[56:57], v[32:33], v[18:19], v[56:57] op_sel:[0,1,0] op_sel_hi:[1,1,1]
  v_pk_fma_f32 v[58:59], v[34:35], v[18:19], v[58:59] op_sel:[0,1,0] op_sel_hi:[1,1,1]
  buffer_load_dwordx4 v[132:135], v2, s[48:51], s12 offen offset:0 nt
  buffer_load_dwordx4 v[136:139], v2, s[48:51], s12 offen offset:128 nt
  buffer_load_dwordx4 v[140:143], v2, s[48:51], s12 offen offset:256 nt
  buffer_load_dwordx4 v[144:147], v2, s[48:51], s12 offen offset:1536 nt
  buffer_load_dwordx4 v[148:151], v2, s[48:51], s12 offen offset:1664 nt
  buffer_load_dwordx4 v[152:155], v2, s[48:51], s12 offen offset:1792 nt
  s_waitcnt vmcnt(42)
  v_lshlrev_b32 v28, 16, v156
  v_and_b32 v29, s15, v156
  v_lshlrev_b32 v30, 16, v157
  v_and_b32 v31, s15, v157
  v_lshlrev_b32 v32, 16, v158
  v_and_b32 v33, s15, v158
  v_pk_fma_f32 v[36:37], v[28:29], v[20:21], v[36:37] op_sel_hi:[1,0,1]
  v_lshlrev_b32 v34, 16, v159
  v_and_b32 v35, s15, v159
  v_pk_fma_f32 v[38:39], v[30:31], v[20:21], v[38:39] op_sel_hi:[1,0,1]
  v_lshlrev_b32 v28, 16, v160
  v_and_b32 v29, s15, v160
  v_pk_fma_f32 v[40:41], v[32:33], v[20:21], v[40:41] op_sel_hi:[1,0,1]
  v_lshlrev_b32 v30, 16, v161
  v_and_b32 v31, s15, v161
  v_pk_fma_f32 v[42:43], v[34:35], v[20:21], v[42:43] op_sel_hi:[1,0,1]
  v_lshlrev_b32 v32, 16, v162
  v_and_b32 v33, s15, v162
  v_pk_fma_f32 v[44:45], v[28:29], v[20:21], v[44:45] op_sel_hi:[1,0,1]
  v_lshlrev_b32 v34, 16, v163
  v_and_b32 v35, s15, v163
  v_pk_fma_f32 v[46:47], v[30:31], v[20:21], v[46:47] op_sel_hi:[1,0,1]
  v_lshlrev_b32 v28, 16, v164
  v_and_b32 v29, s15, v164
  v_pk_fma_f32 v[48:49], v[32:33], v[20:21], v[48:49] op_sel_hi:[1,0,1]
  v_lshlrev_b32 v30, 16, v165
  v_and_b32 v31, s15, v165
  v_pk_fma_f32 v[50:51], v[34:35], v[20:21], v[50:51] op_sel_hi:[1,0,1]
  v_lshlrev_b32 v32, 16, v166
  v_and_b32 v33, s15, v166
  v_pk_fma_f32 v[52:53], v[28:29], v[20:21], v[52:53] op_sel_hi:[1,0,1]
  v_lshlrev_b32 v34, 16, v167
  v_and_b32 v35, s15, v167
  v_pk_fma_f32 v[54:55], v[30:31], v[20:21], v[54:55] op_sel_hi:[1,0,1]
  v_lshlrev_b32 v28, 16, v168
  v_and_b32 v29, s15, v168
  v_pk_fma_f32 v[56:57], v[32:33], v[20:21], v[56:57] op_sel_hi:[1,0,1]
  v_lshlrev_b32 v30, 16, v169
  v_and_b32 v31, s15, v169
  v_pk_fma_f32 v[58:59], v[34:35], v[20:21], v[58:59] op_sel_hi:[1,0,1]
  v_lshlrev_b32 v32, 16, v170
  v_and_b32 v33, s15, v170
  v_pk_fma_f32 v[36:37], v[28:29], v[20:21], v[36:37] op_sel:[0,1,0] op_sel_hi:[1,1,1]
  v_lshlrev_b32 v34, 16, v171
  v_and_b32 v35, s15, v171
  v_pk_fma_f32 v[38:39], v[30:31], v[20:21], v[38:39] op_sel:[0,1,0] op_sel_hi:[1,1,1]
  v_lshlrev_b32 v28, 16, v172
  v_and_b32 v29, s15, v172
  v_pk_fma_f32 v[40:41], v[32:33], v[20:21], v[40:41] op_sel:[0,1,0] op_sel_hi:[1,1,1]
  v_lshlrev_b32 v30, 16, v173
  v_and_b32 v31, s15, v173
  v_pk_fma_f32 v[42:43], v[34:35], v[20:21], v[42:43] op_sel:[0,1,0] op_sel_hi:[1,1,1]
  v_lshlrev_b32 v32, 16, v174
  v_and_b32 v33, s15, v174
  v_pk_fma_f32 v[44:45], v[28:29], v[20:21], v[44:45] op_sel:[0,1,0] op_sel_hi:[1,1,1]
  v_lshlrev_b32 v34, 16, v175
  v_and_b32 v35, s15, v175
  v_pk_fma_f32 v[46:47], v[30:31], v[20:21], v[46:47] op_sel:[0,1,0] op_sel_hi:[1,1,1]
  v_lshlrev_b32 v28, 16, v176
  v_and_b32 v29, s15, v176
  v_pk_fma_f32 v[48:49], v[32:33], v[20:21], v[48:49] op_sel:[0,1,0] op_sel_hi:[1,1,1]
  v_lshlrev_b32 v30, 16, v177
  v_and_b32 v31, s15, v177
  v_pk_fma_f32 v[50:51], v[34:35], v[20:21], v[50:51] op_sel:[0,1,0] op_sel_hi:[1,1,1]
  v_lshlrev_b32 v32, 16, v178
  v_and_b32 v33, s15, v178
  v_pk_fma_f32 v[52:53], v[28:29], v[20:21], v[52:53] op_sel:[0,1,0] op_sel_hi:[1,1,1]
  v_lshlrev_b32 v34, 16, v179
  v_and_b32 v35, s15, v179
  v_pk_fma_f32 v[54:55], v[30:31], v[20:21], v[54:55] op_sel:[0,1,0] op_sel_hi:[1,1,1]
  v_pk_fma_f32 v[56:57], v[32:33], v[20:21], v[56:57] op_sel:[0,1,0] op_sel_hi:[1,1,1]
  v_pk_fma_f32 v[58:59], v[34:35], v[20:21], v[58:59] op_sel:[0,1,0] op_sel_hi:[1,1,1]
  s_waitcnt vmcnt(36)
  v_lshlrev_b32 v28, 16, v180
  v_and_b32 v29, s15, v180
  v_lshlrev_b32 v30, 16, v181
  v_and_b32 v31, s15, v181
  v_lshlrev_b32 v32, 16, v182
  v_and_b32 v33, s15, v182
  v_pk_fma_f32 v[36:37], v[28:29], v[22:23], v[36:37] op_sel_hi:[1,0,1]
  v_lshlrev_b32 v34, 16, v183
  v_and_b32 v35, s15, v183
  v_pk_fma_f32 v[38:39], v[30:31], v[22:23], v[38:39] op_sel_hi:[1,0,1]
  v_lshlrev_b32 v28, 16, v184
  v_and_b32 v29, s15, v184
  v_pk_fma_f32 v[40:41], v[32:33], v[22:23], v[40:41] op_sel_hi:[1,0,1]
  v_lshlrev_b32 v30, 16, v185
  v_and_b32 v31, s15, v185
  v_pk_fma_f32 v[42:43], v[34:35], v[22:23], v[42:43] op_sel_hi:[1,0,1]
  v_lshlrev_b32 v32, 16, v186
  v_and_b32 v33, s15, v186
  v_pk_fma_f32 v[44:45], v[28:29], v[22:23], v[44:45] op_sel_hi:[1,0,1]
  v_lshlrev_b32 v34, 16, v187
  v_and_b32 v35, s15, v187
  v_pk_fma_f32 v[46:47], v[30:31], v[22:23], v[46:47] op_sel_hi:[1,0,1]
  v_lshlrev_b32 v28, 16, v188
  v_and_b32 v29, s15, v188
  v_pk_fma_f32 v[48:49], v[32:33], v[22:23], v[48:49] op_sel_hi:[1,0,1]
  v_lshlrev_b32 v30, 16, v189
  v_and_b32 v31, s15, v189
  v_pk_fma_f32 v[50:51], v[34:35], v[22:23], v[50:51] op_sel_hi:[1,0,1]
  v_lshlrev_b32 v32, 16, v190
  v_and_b32 v33, s15, v190
  v_pk_fma_f32 v[52:53], v[28:29], v[22:23], v[52:53] op_sel_hi:[1,0,1]
  v_lshlrev_b32 v34, 16, v191
  v_and_b32 v35, s15, v191
  v_pk_fma_f32 v[54:55], v[30:31], v[22:23], v[54:55] op_sel_hi:[1,0,1]
  v_lshlrev_b32 v28, 16, v192
  v_and_b32 v29, s15, v192
  v_pk_fma_f32 v[56:57], v[32:33], v[22:23], v[56:57] op_sel_hi:[1,0,1]
  v_lshlrev_b32 v30, 16, v193
  v_and_b32 v31, s15, v193
  v_pk_fma_f32 v[58:59], v[34:35], v[22:23], v[58:59] op_sel_hi:[1,0,1]
  v_lshlrev_b32 v32, 16, v194
  v_and_b32 v33, s15, v194
  v_pk_fma_f32 v[36:37], v[28:29], v[22:23], v[36:37] op_sel:[0,1,0] op_sel_hi:[1,1,1]
  v_lshlrev_b32 v34, 16, v195
  v_and_b32 v35, s15, v195
  v_pk_fma_f32 v[38:39], v[30:31], v[22:23], v[38:39] op_sel:[0,1,0] op_sel_hi:[1,1,1]
  v_lshlrev_b32 v28, 16, v196
  v_and_b32 v29, s15, v196
  v_pk_fma_f32 v[40:41], v[32:33], v[22:23], v[40:41] op_sel:[0,1,0] op_sel_hi:[1,1,1]
  v_lshlrev_b32 v30, 16, v197
  v_and_b32 v31, s15, v197
  v_pk_fma_f32 v[42:43], v[34:35], v[22:23], v[42:43] op_sel:[0,1,0] op_sel_hi:[1,1,1]
  v_lshlrev_b32 v32, 16, v198
  v_and_b32 v33, s15, v198
  v_pk_fma_f32 v[44:45], v[28:29], v[22:23], v[44:45] op_sel:[0,1,0] op_sel_hi:[1,1,1]
  v_lshlrev_b32 v34, 16, v199
  v_and_b32 v35, s15, v199
  v_pk_fma_f32 v[46:47], v[30:31], v[22:23], v[46:47] op_sel:[0,1,0] op_sel_hi:[1,1,1]
  v_lshlrev_b32 v28, 16, v200
  v_and_b32 v29, s15, v200
  v_pk_fma_f32 v[48:49], v[32:33], v[22:23], v[48:49] op_sel:[0,1,0] op_sel_hi:[1,1,1]
  v_lshlrev_b32 v30, 16, v201
  v_and_b32 v31, s15, v201
  v_pk_fma_f32 v[50:51], v[34:35], v[22:23], v[50:51] op_sel:[0,1,0] op_sel_hi:[1,1,1]
  v_lshlrev_b32 v32, 16, v202
  v_and_b32 v33, s15, v202
  v_pk_fma_f32 v[52:53], v[28:29], v[22:23], v[52:53] op_sel:[0,1,0] op_sel_hi:[1,1,1]
  v_lshlrev_b32 v34, 16, v203
  v_and_b32 v35, s15, v203
  v_pk_fma_f32 v[54:55], v[30:31], v[22:23], v[54:55] op_sel:[0,1,0] op_sel_hi:[1,1,1]
  v_pk_fma_f32 v[56:57], v[32:33], v[22:23], v[56:57] op_sel:[0,1,0] op_sel_hi:[1,1,1]
  v_pk_fma_f32 v[58:59], v[34:35], v[22:23], v[58:59] op_sel:[0,1,0] op_sel_hi:[1,1,1]
  s_waitcnt vmcnt(30)
  v_lshlrev_b32 v28, 16, v204
  v_and_b32 v29, s15, v204
  v_lshlrev_b32 v30, 16, v205
  v_and_b32 v31, s15, v205
  v_lshlrev_b32 v32, 16, v206
  v_and_b32 v33, s15, v206
  v_pk_fma_f32 v[36:37], v[28:29], v[24:25], v[36:37] op_sel_hi:[1,0,1]
  v_lshlrev_b32 v34, 16, v207
  v_and_b32 v35, s15, v207
  v_pk_fma_f32 v[38:39], v[30:31], v[24:25], v[38:39] op_sel_hi:[1,0,1]
  v_lshlrev_b32 v28, 16, v208
  v_and_b32 v29, s15, v208
  v_pk_fma_f32 v[40:41], v[32:33], v[24:25], v[40:41] op_sel_hi:[1,0,1]
  v_lshlrev_b32 v30, 16, v209
  v_and_b32 v31, s15, v209
  v_pk_fma_f32 v[42:43], v[34:35], v[24:25], v[42:43] op_sel_hi:[1,0,1]
  v_lshlrev_b32 v32, 16, v210
  v_and_b32 v33, s15, v210
  v_pk_fma_f32 v[44:45], v[28:29], v[24:25], v[44:45] op_sel_hi:[1,0,1]
  v_lshlrev_b32 v34, 16, v211
  v_and_b32 v35, s15, v211
  v_pk_fma_f32 v[46:47], v[30:31], v[24:25], v[46:47] op_sel_hi:[1,0,1]
  v_lshlrev_b32 v28, 16, v212
  v_and_b32 v29, s15, v212
  v_pk_fma_f32 v[48:49], v[32:33], v[24:25], v[48:49] op_sel_hi:[1,0,1]
  v_lshlrev_b32 v30, 16, v213
  v_and_b32 v31, s15, v213
  v_pk_fma_f32 v[50:51], v[34:35], v[24:25], v[50:51] op_sel_hi:[1,0,1]
  v_lshlrev_b32 v32, 16, v214
  v_and_b32 v33, s15, v214
  v_pk_fma_f32 v[52:53], v[28:29], v[24:25], v[52:53] op_sel_hi:[1,0,1]
  v_lshlrev_b32 v34, 16, v215
  v_and_b32 v35, s15, v215
  v_pk_fma_f32 v[54:55], v[30:31], v[24:25], v[54:55] op_sel_hi:[1,0,1]
  v_lshlrev_b32 v28, 16, v216
  v_and_b32 v29, s15, v216
  v_pk_fma_f32 v[56:57], v[32:33], v[24:25], v[56:57] op_sel_hi:[1,0,1]
  v_lshlrev_b32 v30, 16, v217
  v_and_b32 v31, s15, v217
  v_pk_fma_f32 v[58:59], v[34:35], v[24:25], v[58:59] op_sel_hi:[1,0,1]
  v_lshlrev_b32 v32, 16, v218
  v_and_b32 v33, s15, v218
  v_pk_fma_f32 v[36:37], v[28:29], v[24:25], v[36:37] op_sel:[0,1,0] op_sel_hi:[1,1,1]
  v_lshlrev_b32 v34, 16, v219
  v_and_b32 v35, s15, v219
  v_pk_fma_f32 v[38:39], v[30:31], v[24:25], v[38:39] op_sel:[0,1,0] op_sel_hi:[1,1,1]
  v_lshlrev_b32 v28, 16, v220
  v_and_b32 v29, s15, v220
  v_pk_fma_f32 v[40:41], v[32:33], v[24:25], v[40:41] op_sel:[0,1,0] op_sel_hi:[1,1,1]
  v_lshlrev_b32 v30, 16, v221
  v_and_b32 v31, s15, v221
  v_pk_fma_f32 v[42:43], v[34:35], v[24:25], v[42:43] op_sel:[0,1,0] op_sel_hi:[1,1,1]
  v_lshlrev_b32 v32, 16, v222
  v_and_b32 v33, s15, v222
  v_pk_fma_f32 v[44:45], v[28:29], v[24:25], v[44:45] op_sel:[0,1,0] op_sel_hi:[1,1,1]
  v_lshlrev_b32 v34, 16, v223
  v_and_b32 v35, s15, v223
  v_pk_fma_f32 v[46:47], v[30:31], v[24:25], v[46:47] op_sel:[0,1,0] op_sel_hi:[1,1,1]
  v_lshlrev_b32 v28, 16, v224
  v_and_b32 v29, s15, v224
  v_pk_fma_f32 v[48:49], v[32:33], v[24:25], v[48:49] op_sel:[0,1,0] op_sel_hi:[1,1,1]
  v_lshlrev_b32 v30, 16, v225
  v_and_b32 v31, s15, v225
  v_pk_fma_f32 v[50:51], v[34:35], v[24:25], v[50:51] op_sel:[0,1,0] op_sel_hi:[1,1,1]
  v_lshlrev_b32 v32, 16, v226
  v_and_b32 v33, s15, v226
  v_pk_fma_f32 v[52:53], v[28:29], v[24:25], v[52:53] op_sel:[0,1,0] op_sel_hi:[1,1,1]
  v_lshlrev_b32 v34, 16, v227
  v_and_b32 v35, s15, v227
  v_pk_fma_f32 v[54:55], v[30:31], v[24:25], v[54:55] op_sel:[0,1,0] op_sel_hi:[1,1,1]
  v_pk_fma_f32 v[56:57], v[32:33], v[24:25], v[56:57] op_sel:[0,1,0] op_sel_hi:[1,1,1]
  v_pk_fma_f32 v[58:59], v[34:35], v[24:25], v[58:59] op_sel:[0,1,0] op_sel_hi:[1,1,1]
  s_waitcnt vmcnt(24)
  v_lshlrev_b32 v28, 16, v228
  v_and_b32 v29, s15, v228
  v_lshlrev_b32 v30, 16, v229
  v_and_b32 v31, s15, v229
  v_lshlrev_b32 v32, 16, v230
  v_and_b32 v33, s15, v230
  v_pk_fma_f32 v[36:37], v[28:29], v[26:27], v[36:37] op_sel_hi:[1,0,1]
  v_lshlrev_b32 v34, 16, v231
  v_and_b32 v35, s15, v231
  v_pk_fma_f32 v[38:39], v[30:31], v[26:27], v[38:39] op_sel_hi:[1,0,1]
  v_lshlrev_b32 v28, 16, v232
  v_and_b32 v29, s15, v232
  v_pk_fma_f32 v[40:41], v[32:33], v[26:27], v[40:41] op_sel_hi:[1,0,1]
  v_lshlrev_b32 v30, 16, v233
  v_and_b32 v31, s15, v233
  v_pk_fma_f32 v[42:43], v[34:35], v[26:27], v[42:43] op_sel_hi:[1,0,1]
  v_lshlrev_b32 v32, 16, v234
  v_and_b32 v33, s15, v234
  v_pk_fma_f32 v[44:45], v[28:29], v[26:27], v[44:45] op_sel_hi:[1,0,1]
  v_lshlrev_b32 v34, 16, v235
  v_and_b32 v35, s15, v235
  v_pk_fma_f32 v[46:47], v[30:31], v[26:27], v[46:47] op_sel_hi:[1,0,1]
  v_lshlrev_b32 v28, 16, v236
  v_and_b32 v29, s15, v236
  v_pk_fma_f32 v[48:49], v[32:33], v[26:27], v[48:49] op_sel_hi:[1,0,1]
  v_lshlrev_b32 v30, 16, v237
  v_and_b32 v31, s15, v237
  v_pk_fma_f32 v[50:51], v[34:35], v[26:27], v[50:51] op_sel_hi:[1,0,1]
  v_lshlrev_b32 v32, 16, v238
  v_and_b32 v33, s15, v238
  v_pk_fma_f32 v[52:53], v[28:29], v[26:27], v[52:53] op_sel_hi:[1,0,1]
  v_lshlrev_b32 v34, 16, v239
  v_and_b32 v35, s15, v239
  v_pk_fma_f32 v[54:55], v[30:31], v[26:27], v[54:55] op_sel_hi:[1,0,1]
  v_lshlrev_b32 v28, 16, v240
  v_and_b32 v29, s15, v240
  v_pk_fma_f32 v[56:57], v[32:33], v[26:27], v[56:57] op_sel_hi:[1,0,1]
  v_lshlrev_b32 v30, 16, v241
  v_and_b32 v31, s15, v241
  v_pk_fma_f32 v[58:59], v[34:35], v[26:27], v[58:59] op_sel_hi:[1,0,1]
  v_lshlrev_b32 v32, 16, v242
  v_and_b32 v33, s15, v242
  v_pk_fma_f32 v[36:37], v[28:29], v[26:27], v[36:37] op_sel:[0,1,0] op_sel_hi:[1,1,1]
  v_lshlrev_b32 v34, 16, v243
  v_and_b32 v35, s15, v243
  v_pk_fma_f32 v[38:39], v[30:31], v[26:27], v[38:39] op_sel:[0,1,0] op_sel_hi:[1,1,1]
  v_lshlrev_b32 v28, 16, v244
  v_and_b32 v29, s15, v244
  v_pk_fma_f32 v[40:41], v[32:33], v[26:27], v[40:41] op_sel:[0,1,0] op_sel_hi:[1,1,1]
  v_lshlrev_b32 v30, 16, v245
  v_and_b32 v31, s15, v245
  v_pk_fma_f32 v[42:43], v[34:35], v[26:27], v[42:43] op_sel:[0,1,0] op_sel_hi:[1,1,1]
  v_lshlrev_b32 v32, 16, v246
  v_and_b32 v33, s15, v246
  v_pk_fma_f32 v[44:45], v[28:29], v[26:27], v[44:45] op_sel:[0,1,0] op_sel_hi:[1,1,1]
  v_lshlrev_b32 v34, 16, v247
  v_and_b32 v35, s15, v247
  v_pk_fma_f32 v[46:47], v[30:31], v[26:27], v[46:47] op_sel:[0,1,0] op_sel_hi:[1,1,1]
  v_lshlrev_b32 v28, 16, v248
  v_and_b32 v29, s15, v248
  v_pk_fma_f32 v[48:49], v[32:33], v[26:27], v[48:49] op_sel:[0,1,0] op_sel_hi:[1,1,1]
  v_lshlrev_b32 v30, 16, v249
  v_and_b32 v31, s15, v249
  v_pk_fma_f32 v[50:51], v[34:35], v[26:27], v[50:51] op_sel:[0,1,0] op_sel_hi:[1,1,1]
  v_lshlrev_b32 v32, 16, v250
  v_and_b32 v33, s15, v250
  v_pk_fma_f32 v[52:53], v[28:29], v[26:27], v[52:53] op_sel:[0,1,0] op_sel_hi:[1,1,1]
  v_lshlrev_b32 v34, 16, v251
  v_and_b32 v35, s15, v251
  v_pk_fma_f32 v[54:55], v[30:31], v[26:27], v[54:55] op_sel:[0,1,0] op_sel_hi:[1,1,1]
  v_pk_fma_f32 v[56:57], v[32:33], v[26:27], v[56:57] op_sel:[0,1,0] op_sel_hi:[1,1,1]
  v_pk_fma_f32 v[58:59], v[34:35], v[26:27], v[58:59] op_sel:[0,1,0] op_sel_hi:[1,1,1]
  v_add_u32 v3, 1536, v10
  ds_read_b128 v[16:19], v3 offset:0
  ds_read_b128 v[20:23], v3 offset:128
  ds_read_b128 v[24:27], v3 offset:256
  s_waitcnt lgkmcnt(0)
L_loop:
  s_waitcnt vmcnt(18)
  v_mfma_f32_16x16x32_bf16 v[28:31], v[16:19], v[60:63], 0
  v_mfma_f32_16x16x32_bf16 v[32:35], v[16:19], v[72:75], 0
  v_mfma_f32_16x16x32_bf16 v[28:31], v[20:23], v[64:67], v[28:31]
  v_mfma_f32_16x16x32_bf16 v[32:35], v[20:23], v[76:79], v[32:35]
  v_mfma_f32_16x16x32_bf16 v[28:31], v[24:27], v[68:71], v[28:31]
  v_mfma_f32_16x16x32_bf16 v[32:35], v[24:27], v[80:83], v[32:35]
  s_sub_u32 s6, s6, 1
  s_cmp_gt_i32 s6, 1
  s_cbranch_scc0 L_dyn0
  s_lshr_b32 s8, s7, 6
  s_mul_i32 s8, s8, 393216
  s_and_b32 s9, s7, 63
  s_mul_i32 s10, s9, 3121
  s_lshr_b32 s10, s10, 16
  s_mul_i32 s10, s10, 22
  s_add_u32 s10, s10, s9
  s_cmp_eq_u32 s9, 63
  s_cselect_b32 s10, 42, s10
  s_cselect_b32 s57, 43, 21
  s_mul_i32 s57, s57, 3072
  s_mul_i32 s10, s10, 3072
  s_add_u32 s12, s56, s8
  s_add_u32 s12, s12, s10
  v_mad_u32_u24 v2, v0, s57, v252
  s_add_u32 s7, s7, s80
L_dynret0:
  buffer_load_dwordx4 v[60:63], v2, s[44:47], s12 offen offset:0 nt
  buffer_load_dwordx4 v[64:67], v2, s[44:47], s12 offen offset:128 nt
  buffer_load_dwordx4 v[68:71], v2, s[44:47], s12 offen offset:256 nt
  buffer_load_dwordx4 v[72:75], v2, s[44:47], s12 offen offset:1536 nt
  buffer_load_dwordx4 v[76:79], v2, s[44:47], s12 offen offset:1664 nt
  buffer_load_dwordx4 v[80:83], v2, s[44:47], s12 offen offset:1792 nt
  v_add_f32_dpp v12, v29, v28 row_ror:8 row_mask:0xf bank_mask:0x3
  v_add_f32_dpp v12, v28, v29 row_ror:8 row_mask:0xf bank_mask:0xc
  v_add_f32_dpp v13, v33, v32 row_ror:8 row_mask:0xf bank_mask:0x3
  v_add_f32_dpp v13, v32, v33 row_ror:8 row_mask:0xf bank_mask:0xc
  v_cvt_pk_bf16_f32 v3, v12, v13
  v_lshlrev_b32 v12, 16, v3
  v_and_b32 v13, s15, v3
  v_mul_f32 v12, 0x3d93cd3a, v12
  v_mul_f32 v13, 0x3d93cd3a, v13
  v_cvt_pk_bf16_f32 v3, v12, v13
  v_lshlrev_b32 v12, 16, v3
  v_and_b32 v13, s15, v3
  v_max3_f32 v3, v7, v12, v13
  v_sub_f32 v9, v7, v3
  v_sub_f32 v12, v12, v3
  v_sub_f32 v13, v13, v3
  v_mul_f32 v9, 0x3fb8aa3b, v9
  v_mul_f32 v12, 0x3fb8aa3b, v12
  v_mul_f32 v13, 0x3fb8aa3b, v13
  v_exp_f32 v9, v9
  v_exp_f32 v12, v12
  v_exp_f32 v13, v13
  v_mov_b32 v7, v3
  v_fma_f32 v8, v8, v9, v12
  v_pk_mul_f32 v[36:37], v[36:37], v[8:9] op_sel:[0,1] op_sel_hi:[1,1]
  v_pk_mul_f32 v[38:39], v[38:39], v[8:9] op_sel:[0,1] op_sel_hi:[1,1]
  v_pk_mul_f32 v[40:41], v[40:41], v[8:9] op_sel:[0,1] op_sel_hi:[1,1]
  v_pk_mul_f32 v[42:43], v[42:43], v[8:9] op_sel:[0,1] op_sel_hi:[1,1]
  v_pk_mul_f32 v[44:45], v[44:45], v[8:9] op_sel:[0,1] op_sel_hi:[1,1]
  v_pk_mul_f32 v[46:47], v[46:47], v[8:9] op_sel:[0,1] op_sel_hi:[1,1]
  v_pk_mul_f32 v[48:49], v[48:49], v[8:9] op_sel:[0,1] op_sel_hi:[1,1]
  v_pk_mul_f32 v[50:51], v[50:51], v[8:9] op_sel:[0,1] op_sel_hi:[1,1]
  v_pk_mul_f32 v[52:53], v[52:53], v[8:9] op_sel:[0,1] op_sel_hi:[1,1]
  v_pk_mul_f32 v[54:55], v[54:55], v[8:9] op_sel:[0,1] op_sel_hi:[1,1]
  v_pk_mul_f32 v[56:57], v[56:57], v[8:9] op_sel:[0,1] op_sel_hi:[1,1]
  v_pk_mul_f32 v[58:59], v[58:59], v[8:9] op_sel:[0,1] op_sel_hi:[1,1]
  v_add_f32 v8, v8, v13
  s_waitcnt vmcnt(18)
  v_lshlrev_b32 v28, 16, v84
  v_and_b32 v29, s15, v84
  v_lshlrev_b32 v30, 16, v85
  v_and_b32 v31, s15, v85
  v_lshlrev_b32 v32, 16, v86
  v_and_b32 v33, s15, v86
  v_pk_fma_f32 v[36:37], v[28:29], v[12:13], v[36:37] op_sel_hi:[1,0,1]
  v_lshlrev_b32 v34, 16, v87
  v_and_b32 v35, s15, v87
  v_pk_fma_f32 v[38:39], v[30:31], v[12:13], v[38:39] op_sel_hi:[1,0,1]
  v_lshlrev_b32 v28, 16, v88
  v_and_b32 v29, s15, v88
  v_pk_fma_f32 v[40:41], v[32:33], v[12:13], v[40:41] op_sel_hi:[1,0,1]
  v_lshlrev_b32 v30, 16, v89
  v_and_b32 v31, s15, v89
  v_pk_fma_f32 v[42:43], v[34:35], v[12:13], v[42:43] op_sel_hi:[1,0,1]
  v_lshlrev_b32 v32, 16, v90
  v_and_b32 v33, s15, v90
  v_pk_fma_f32 v[44:45], v[28:29], v[12:13], v[44:45] op_sel_hi:[1,0,1]
  v_lshlrev_b32 v34, 16, v91
  v_and_b32 v35, s15, v91
  v_pk_fma_f32 v[46:47], v[30:31], v[12:13], v[46:47] op_sel_hi:[1,0,1]
  v_lshlrev_b32 v28, 16, v92
  v_and_b32 v29, s15, v92
  v_pk_fma_f32 v[48:49], v[32:33], v[12:13], v[48:49] op_sel_hi:[1,0,1]
  v_lshlrev_b32 v30, 16, v93
  v_and_b32 v31, s15, v93
  v_pk_fma_f32 v[50:51], v[34:35], v[12:13], v[50:51] op_sel_hi:[1,0,1]
  v_lshlrev_b32 v32, 16, v94
  v_and_b32 v33, s15, v94
  v_pk_fma_f32 v[52:53], v[28:29], v[12:13], v[52:53] op_sel_hi:[1,0,1]
  v_lshlrev_b32 v34, 16, v95
  v_and_b32 v35, s15, v95
  v_pk_fma_f32 v[54:55], v[30:31], v[12:13], v[54:55] op_sel_hi:[1,0,1]
  v_lshlrev_b32 v28, 16, v96
  v_and_b32 v29, s15, v96
  v_pk_fma_f32 v[56:57], v[32:33], v[12:13], v[56:57] op_sel_hi:[1,0,1]
  v_lshlrev_b32 v30, 16, v97
  v_and_b32 v31, s15, v97
  v_pk_fma_f32 v[58:59], v[34:35], v[12:13], v[58:59] op_sel_hi:[1,0,1]
  v_lshlrev_b32 v32, 16, v98
  v_and_b32 v33, s15, v98
  v_pk_fma_f32 v[36:37], v[28:29], v[12:13], v[36:37] op_sel:[0,1,0] op_sel_hi:[1,1,1]
  v_lshlrev_b32 v34, 16, v99
  v_and_b32 v35, s15, v99
  v_pk_fma_f32 v[38:39], v[30:31], v[12:13], v[38:39] op_sel:[0,1,0] op_sel_hi:[1,1,1]
  v_lshlrev_b32 v28, 16, v100
  v_and_b32 v29, s15, v100
  v_pk_fma_f32 v[40:41], v[32:33], v[12:13], v[40:41] op_sel:[0,1,0] op_sel_hi:[1,1,1]
  v_lshlrev_b32 v30, 16, v101
  v_and_b32 v31, s15, v101
  v_pk_fma_f32 v[42:43], v[34:35], v[12:13], v[42:43] op_sel:[0,1,0] op_sel_hi:[1,1,1]
  v_lshlrev_b32 v32, 16, v102
  v_and_b32 v33, s15, v102
  v_pk_fma_f32 v[44:45], v[28:29], v[12:13], v[44:45] op_sel:[0,1,0] op_sel_hi:[1,1,1]
  v_lshlrev_b32 v34, 16, v103
  v_and_b32 v35, s15, v103
  v_pk_fma_f32 v[46:47], v[30:31], v[12:13], v[46:47] op_sel:[0,1,0] op_sel_hi:[1,1,1]
  v_lshlrev_b32 v28, 16, v104
  v_and_b32 v29, s15, v104
  v_pk_fma_f32 v[48:49], v[32:33], v[12:13], v[48:49] op_sel:[0,1,0] op_sel_hi:[1,1,1]
  v_lshlrev_b32 v30, 16, v105
  v_and_b32 v31, s15, v105
  v_pk_fma_f32 v[50:51], v[34:35], v[12:13], v[50:51] op_sel:[0,1,0] op_sel_hi:[1,1,1]
  v_lshlrev_b32 v32, 16, v106
  v_and_b32 v33, s15, v106
  v_pk_fma_f32 v[52:53], v[28:29], v[12:13], v[52:53] op_sel:[0,1,0] op_sel_hi:[1,1,1]
  v_lshlrev_b32 v34, 16, v107
  v_and_b32 v35, s15, v107
  v_pk_fma_f32 v[54:55], v[30:31], v[12:13], v[54:55] op_sel:[0,1,0] op_sel_hi:[1,1,1]
  v_pk_fma_f32 v[56:57], v[32:33], v[12:13], v[56:57] op_sel:[0,1,0] op_sel_hi:[1,1,1]
  v_pk_fma_f32 v[58:59], v[34:35], v[12:13], v[58:59] op_sel:[0,1,0] op_sel_hi:[1,1,1]
  buffer_load_dwordx4 v[84:87], v2, s[48:51], s12 offen offset:0 nt
  buffer_load_dwordx4 v[88:91], v2, s[48:51], s12 offen offset:128 nt
  buffer_load_dwordx4 v[92:95], v2, s[48:51], s12 offen offset:256 nt
  buffer_load_dwordx4 v[96:99], v2, s[48:51], s12 offen offset:1536 nt
  buffer_load_dwordx4 v[100:103], v2, s[48:51], s12 offen offset:1664 nt
  buffer_load_dwordx4 v[104:107], v2, s[48:51], s12 offen offset:1792 nt
  s_waitcnt vmcnt(18)
  v_mfma_f32_16x16x32_bf16 v[28:31], v[16:19], v[108:111], 0
  v_mfma_f32_16x16x32_bf16 v[32:35], v[16:19], v[120:123], 0
  v_mfma_f32_16x16x32_bf16 v[28:31], v[20:23], v[112:115], v[28:31]
  v_mfma_f32_16x16x32_bf16 v[32:35], v[20:23], v[124:127], v[32:35]
  v_mfma_f32_16x16x32_bf16 v[28:31], v[24:27], v[116:119], v[28:31]
  v_mfma_f32_16x16x32_bf16 v[32:35], v[24:27], v[128:131], v[32:35]
  s_sub_u32 s6, s6, 1
  s_cmp_gt_i32 s6, 1
  s_cbranch_scc0 L_dyn1
  s_lshr_b32 s8, s7, 6
  s_mul_i32 s8, s8, 393216
  s_and_b32 s9, s7, 63
  s_mul_i32 s10, s9, 3121
  s_lshr_b32 s10, s10, 16
  s_mul_i32 s10, s10, 22
  s_add_u32 s10, s10, s9
  s_cmp_eq_u32 s9, 63
  s_cselect_b32 s10, 42, s10
  s_cselect_b32 s57, 43, 21
  s_mul_i32 s57, s57, 3072
  s_mul_i32 s10, s10, 3072
  s_add_u32 s12, s56, s8
  s_add_u32 s12, s12, s10
  v_mad_u32_u24 v2, v0, s57, v252
  s_add_u32 s7, s7, s80
L_dynret1:
  buffer_load_dwordx4 v[108:111], v2, s[44:47], s12 offen offset:0 nt
  buffer_load_dwordx4 v[112:115], v2, s[44:47], s12 offen offset:128 nt
  buffer_load_dwordx4 v[116:119], v2, s[44:47], s12 offen offset:256 nt
  buffer_load_dwordx4 v[120:123], v2, s[44:47], s12 offen offset:1536 nt
  buffer_load_dwordx4 v[124:127], v2, s[44:47], s12 offen offset:1664 nt
  buffer_load_dwordx4 v[128:131], v2, s[44:47], s12 offen offset:1792 nt
  v_add_f32_dpp v12, v29, v28 row_ror:8 row_mask:0xf bank_mask:0x3
  v_add_f32_dpp v12, v28, v29 row_ror:8 row_mask:0xf bank_mask:0xc
  v_add_f32_dpp v13, v33, v32 row_ror:8 row_mask:0xf bank_mask:0x3
  v_add_f32_dpp v13, v32, v33 row_ror:8 row_mask:0xf bank_mask:0xc
  v_cvt_pk_bf16_f32 v3, v12, v13
  v_lshlrev_b32 v12, 16, v3
  v_and_b32 v13, s15, v3
  v_mul_f32 v12, 0x3d93cd3a, v12
  v_mul_f32 v13, 0x3d93cd3a, v13
  v_cvt_pk_bf16_f32 v3, v12, v13
  v_lshlrev_b32 v12, 16, v3
  v_and_b32 v13, s15, v3
  v_max3_f32 v3, v7, v12, v13
  v_sub_f32 v9, v7, v3
  v_sub_f32 v12, v12, v3
  v_sub_f32 v13, v13, v3
  v_mul_f32 v9, 0x3fb8aa3b, v9
  v_mul_f32 v12, 0x3fb8aa3b, v12
  v_mul_f32 v13, 0x3fb8aa3b, v13
  v_exp_f32 v9, v9
  v_exp_f32 v12, v12
  v_exp_f32 v13, v13
  v_mov_b32 v7, v3
  v_fma_f32 v8, v8, v9, v12
  v_pk_mul_f32 v[36:37], v[36:37], v[8:9] op_sel:[0,1] op_sel_hi:[1,1]
  v_pk_mul_f32 v[38:39], v[38:39], v[8:9] op_sel:[0,1] op_sel_hi:[1,1]
  v_pk_mul_f32 v[40:41], v[40:41], v[8:9] op_sel:[0,1] op_sel_hi:[1,1]
  v_pk_mul_f32 v[42:43], v[42:43], v[8:9] op_sel:[0,1] op_sel_hi:[1,1]
  v_pk_mul_f32 v[44:45], v[44:45], v[8:9] op_sel:[0,1] op_sel_hi:[1,1]
  v_pk_mul_f32 v[46:47], v[46:47], v[8:9] op_sel:[0,1] op_sel_hi:[1,1]
  v_pk_mul_f32 v[48:49], v[48:49], v[8:9] op_sel:[0,1] op_sel_hi:[1,1]
  v_pk_mul_f32 v[50:51], v[50:51], v[8:9] op_sel:[0,1] op_sel_hi:[1,1]
  v_pk_mul_f32 v[52:53], v[52:53], v[8:9] op_sel:[0,1] op_sel_hi:[1,1]
  v_pk_mul_f32 v[54:55], v[54:55], v[8:9] op_sel:[0,1] op_sel_hi:[1,1]
  v_pk_mul_f32 v[56:57], v[56:57], v[8:9] op_sel:[0,1] op_sel_hi:[1,1]
  v_pk_mul_f32 v[58:59], v[58:59], v[8:9] op_sel:[0,1] op_sel_hi:[1,1]
  v_add_f32 v8, v8, v13
  s_waitcnt vmcnt(18)
  v_lshlrev_b32 v28, 16, v132
  v_and_b32 v29, s15, v132
  v_lshlrev_b32 v30, 16, v133
  v_and_b32 v31, s15, v133
  v_lshlrev_b32 v32, 16, v134
  v_and_b32 v33, s15, v134
  v_pk_fma_f32 v[36:37], v[28:29], v[12:13], v[36:37] op_sel_hi:[1,0,1]
  v_lshlrev_b32 v34, 16, v135
  v_and_b32 v35, s15, v135
  v_pk_fma_f32 v[38:39], v[30:31], v[12:13], v[38:39] op_sel_hi:[1,0,1]
  v_lshlrev_b32 v28, 16, v136
  v_and_b32 v29, s15, v136
  v_pk_fma_f32 v[40:41], v[32:33], v[12:13], v[40:41] op_sel_hi:[1,0,1]
  v_lshlrev_b32 v30, 16, v137
  v_and_b32 v31, s15, v137
  v_pk_fma_f32 v[42:43], v[34:35], v[12:13], v[42:43] op_sel_hi:[1,0,1]
  v_lshlrev_b32 v32, 16, v138
  v_and_b32 v33, s15, v138
  v_pk_fma_f32 v[44:45], v[28:29], v[12:13], v[44:45] op_sel_hi:[1,0,1]
  v_lshlrev_b32 v34, 16, v139
  v_and_b32 v35, s15, v139
  v_pk_fma_f32 v[46:47], v[30:31], v[12:13], v[46:47] op_sel_hi:[1,0,1]
  v_lshlrev_b32 v28, 16, v140
  v_and_b32 v29, s15, v140
  v_pk_fma_f32 v[48:49], v[32:33], v[12:13], v[48:49] op_sel_hi:[1,0,1]
  v_lshlrev_b32 v30, 16, v141
  v_and_b32 v31, s15, v141
  v_pk_fma_f32 v[50:51], v[34:35], v[12:13], v[50:51] op_sel_hi:[1,0,1]
  v_lshlrev_b32 v32, 16, v142
  v_and_b32 v33, s15, v142
  v_pk_fma_f32 v[52:53], v[28:29], v[12:13], v[52:53] op_sel_hi:[1,0,1]
  v_lshlrev_b32 v34, 16, v143
  v_and_b32 v35, s15, v143
  v_pk_fma_f32 v[54:55], v[30:31], v[12:13], v[54:55] op_sel_hi:[1,0,1]
  v_lshlrev_b32 v28, 16, v144
  v_and_b32 v29, s15, v144
  v_pk_fma_f32 v[56:57], v[32:33], v[12:13], v[56:57] op_sel_hi:[1,0,1]
  v_lshlrev_b32 v30, 16, v145
  v_and_b32 v31, s15, v145
  v_pk_fma_f32 v[58:59], v[34:35], v[12:13], v[58:59] op_sel_hi:[1,0,1]
  v_lshlrev_b32 v32, 16, v146
  v_and_b32 v33, s15, v146
  v_pk_fma_f32 v[36:37], v[28:29], v[12:13], v[36:37] op_sel:[0,1,0] op_sel_hi:[1,1,1]
  v_lshlrev_b32 v34, 16, v147
  v_and_b32 v35, s15, v147
  v_pk_fma_f32 v[38:39], v[30:31], v[12:13], v[38:39] op_sel:[0,1,0] op_sel_hi:[1,1,1]
  v_lshlrev_b32 v28, 16, v148
  v_and_b32 v29, s15, v148
  v_pk_fma_f32 v[40:41], v[32:33], v[12:13], v[40:41] op_sel:[0,1,0] op_sel_hi:[1,1,1]
  v_lshlrev_b32 v30, 16, v149
  v_and_b32 v31, s15, v149
  v_pk_fma_f32 v[42:43], v[34:35], v[12:13], v[42:43] op_sel:[0,1,0] op_sel_hi:[1,1,1]
  v_lshlrev_b32 v32, 16, v150
  v_and_b32 v33, s15, v150
  v_pk_fma_f32 v[44:45], v[28:29], v[12:13], v[44:45] op_sel:[0,1,0] op_sel_hi:[1,1,1]
  v_lshlrev_b32 v34, 16, v151
  v_and_b32 v35, s15, v151
  v_pk_fma_f32 v[46:47], v[30:31], v[12:13], v[46:47] op_sel:[0,1,0] op_sel_hi:[1,1,1]
  v_lshlrev_b32 v28, 16, v152
  v_and_b32 v29, s15, v152
  v_pk_fma_f32 v[48:49], v[32:33], v[12:13], v[48:49] op_sel:[0,1,0] op_sel_hi:[1,1,1]
  v_lshlrev_b32 v30, 16, v153
  v_and_b32 v31, s15, v153
  v_pk_fma_f32 v[50:51], v[34:35], v[12:13], v[50:51] op_sel:[0,1,0] op_sel_hi:[1,1,1]
  v_lshlrev_b32 v32, 16, v154
  v_and_b32 v33, s15, v154
  v_pk_fma_f32 v[52:53], v[28:29], v[12:13], v[52:53] op_sel:[0,1,0] op_sel_hi:[1,1,1]
  v_lshlrev_b32 v34, 16, v155
  v_and_b32 v35, s15, v155
  v_pk_fma_f32 v[54:55], v[30:31], v[12:13], v[54:55] op_sel:[0,1,0] op_sel_hi:[1,1,1]
  v_pk_fma_f32 v[56:57], v[32:33], v[12:13], v[56:57] op_sel:[0,1,0] op_sel_hi:[1,1,1]
  v_pk_fma_f32 v[58:59], v[34:35], v[12:13], v[58:59] op_sel:[0,1,0] op_sel_hi:[1,1,1]
  buffer_load_dwordx4 v[132:135], v2, s[48:51], s12 offen offset:0 nt
  buffer_load_dwordx4 v[136:139], v2, s[48:51], s12 offen offset:128 nt
  buffer_load_dwordx4 v[140:143], v2, s[48:51], s12 offen offset:256 nt
  buffer_load_dwordx4 v[144:147], v2, s[48:51], s12 offen offset:1536 nt
  buffer_load_dwordx4 v[148:151], v2, s[48:51], s12 offen offset:1664 nt
  buffer_load_dwordx4 v[152:155], v2, s[48:51], s12 offen offset:1792 nt
  s_branch L_loop
L_dyn0:
  s_cmp_ge_i32 s6, 0
  s_cbranch_scc1 L_take0
  s_cmp_eq_u32 s95, 0
  s_cbranch_scc1 L_now0
  s_waitcnt vmcnt(12)
  s_mov_b32 s95, 0
L_now0:
  s_and_b32 s9, s83, 63
  v_readlane_b32 s8, v5, s9
  s_add_u32 s83, s83, 1
  s_nop 2
  s_cmp_ge_u32 s8, 96
  s_cbranch_scc1 L_last0
  s_add_u32 s9, s8, 96
  s_mov_b32 s6, 0
  s_mul_i32 s10, s8, 2
  s_add_u32 s10, s10, 48
  s_cmp_lt_u32 s8, 48
  s_cselect_b32 s9, s10, s9
  s_cselect_b32 s6, 1, s6
  s_mul_i32 s10, s8, 4
  s_cmp_lt_u32 s8, 24
  s_cselect_b32 s9, s10, s9
  s_cselect_b32 s6, 3, s6
  s_mul_i32 s10, s9, 2731
  s_lshr_b32 s10, s10, 16
  s_mul_i32 s10, s10, 40
  s_add_u32 s7, s9, s10
  s_add_u32 s7, s7, 40
  s_mov_b32 s80, 1
  s_or_b32 s9, s6, s84
  s_cbranch_scc1 L_take0
  s_mov_b32 s95, 1
  s_mov_b32 s84, 1
  s_lshl_b64 exec, 1, s82
  global_atomic_add v5, v11, v6, s[40:41] sc0
  s_mov_b64 exec, -1
  s_add_u32 s82, s82, 1
L_take0:
  s_lshr_b32 s8, s7, 6
  s_mul_i32 s8, s8, 393216
  s_and_b32 s9, s7, 63
  s_mul_i32 s10, s9, 3121
  s_lshr_b32 s10, s10, 16
  s_mul_i32 s10, s10, 22
  s_add_u32 s10, s10, s9
  s_cmp_eq_u32 s9, 63
  s_cselect_b32 s10, 42, s10
  s_cselect_b32 s57, 43, 21
  s_mul_i32 s57, s57, 3072
  s_mul_i32 s10, s10, 3072
  s_add_u32 s12, s56, s8
  s_add_u32 s12, s12, s10
  v_mad_u32_u24 v2, v0, s57, v252
  s_add_u32 s7, s7, s80
  s_cmp_gt_i32 s6, 1
  s_cbranch_scc1 L_dynret0
  s_sub_u32 s8, s82, s83
  s_cmp_gt_u32 s8, s84
  s_cbranch_scc1 L_dynret0
  s_lshl_b64 exec, 1, s82
  global_atomic_add v5, v11, v6, s[40:41] sc0
  s_mov_b64 exec, -1
  s_add_u32 s82, s82, 1
  s_branch L_dynret0
L_dyn1:
  s_cmp_ge_i32 s6, 0
  s_cbranch_scc1 L_take1
  s_cmp_eq_u32 s95, 0
  s_cbranch_scc1 L_now1
  s_waitcnt vmcnt(12)
  s_mov_b32 s95, 0
L_now1:
  s_and_b32 s9, s83, 63
  v_readlane_b32 s8, v5, s9
  s_add_u32 s83, s83, 1
  s_nop 2
  s_cmp_ge_u32 s8, 96
  s_cbranch_scc1 L_last1
  s_add_u32 s9, s8, 96
  s_mov_b32 s6, 0
  s_mul_i32 s10, s8, 2
  s_add_u32 s10, s10, 48
  s_cmp_lt_u32 s8, 48
  s_cselect_b32 s9, s10, s9
  s_cselect_b32 s6, 1, s6
  s_mul_i32 s10, s8, 4
  s_cmp_lt_u32 s8, 24
  s_cselect_b32 s9, s10, s9
  s_cselect_b32 s6, 3, s6
  s_mul_i32 s10, s9, 2731
  s_lshr_b32 s10, s10, 16
  s_mul_i32 s10, s10, 40
  s_add_u32 s7, s9, s10
  s_add_u32 s7, s7, 40
  s_mov_b32 s80, 1
  s_or_b32 s9, s6, s84
  s_cbranch_scc1 L_take1
  s_mov_b32 s95, 1
  s_mov_b32 s84, 1
  s_lshl_b64 exec, 1, s82
  global_atomic_add v5, v11, v6, s[40:41] sc0
  s_mov_b64 exec, -1
  s_add_u32 s82, s82, 1
L_take1:
  s_lshr_b32 s8, s7, 6
  s_mul_i32 s8, s8, 393216
  s_and_b32 s9, s7, 63
  s_mul_i32 s10, s9, 3121
  s_lshr_b32 s10, s10, 16
  s_mul_i32 s10, s10, 22
  s_add_u32 s10, s10, s9
  s_cmp_eq_u32 s9, 63
  s_cselect_b32 s10, 42, s10
  s_cselect_b32 s57, 43, 21
  s_mul_i32 s57, s57, 3072
  s_mul_i32 s10, s10, 3072
  s_add_u32 s12, s56, s8
  s_add_u32 s12, s12, s10
  v_mad_u32_u24 v2, v0, s57, v252
  s_add_u32 s7, s7, s80
  s_cmp_gt_i32 s6, 1
  s_cbranch_scc1 L_dynret1
  s_sub_u32 s8, s82, s83
  s_cmp_gt_u32 s8, s84
  s_cbranch_scc1 L_dynret1
  s_lshl_b64 exec, 1, s82
  global_atomic_add v5, v11, v6, s[40:41] sc0
  s_mov_b64 exec, -1
  s_add_u32 s82, s82, 1
  s_branch L_dynret1
L_flush:
  v_mov_b32 v3, v7
  s_nop 1
  v_max_f32_dpp v3, v3, v3 quad_perm:[1,0,3,2] row_mask:0xf bank_mask:0xf
  s_nop 1
  v_max_f32_dpp v3, v3, v3 quad_perm:[2,3,0,1] row_mask:0xf bank_mask:0xf
  s_nop 1
  v_max_f32_dpp v3, v3, v3 row_half_mirror row_mask:0xf bank_mask:0xf
  v_sub_f32 v9, v7, v3
  v_mul_f32 v9, 0x3fb8aa3b, v9
  v_exp_f32 v9, v9
  s_lshl_b32 s8, s85, 2
  s_add_u32 s8, s8, s42
  s_lshl_b32 s9, s8, 10
  v_mul_f32 v8, v8, v9
  v_pk_mul_f32 v[36:37], v[36:37], v[8:9] op_sel:[0,1] op_sel_hi:[1,1]
  v_pk_mul_f32 v[38:39], v[38:39], v[8:9] op_sel:[0,1] op_sel_hi:[1,1]
  v_pk_mul_f32 v[40:41], v[40:41], v[8:9] op_sel:[0,1] op_sel_hi:[1,1]
  v_pk_mul_f32 v[42:43], v[42:43], v[8:9] op_sel:[0,1] op_sel_hi:[1,1]
  v_pk_mul_f32 v[44:45], v[44:45], v[8:9] op_sel:[0,1] op_sel_hi:[1,1]
  v_pk_mul_f32 v[46:47], v[46:47], v[8:9] op_sel:[0,1] op_sel_hi:[1,1]
  v_pk_mul_f32 v[48:49], v[48:49], v[8:9] op_sel:[0,1] op_sel_hi:[1,1]
  v_pk_mul_f32 v[50:51], v[50:51], v[8:9] op_sel:[0,1] op_sel_hi:[1,1]
  v_pk_mul_f32 v[52:53], v[52:53], v[8:9] op_sel:[0,1] op_sel_hi:[1,1]
  v_pk_mul_f32 v[54:55], v[54:55], v[8:9] op_sel:[0,1] op_sel_hi:[1,1]
  v_pk_mul_f32 v[56:57], v[56:57], v[8:9] op_sel:[0,1] op_sel_hi:[1,1]
  v_pk_mul_f32 v[58:59], v[58:59], v[8:9] op_sel:[0,1] op_sel_hi:[1,1]
  v_add_f32_dpp v8, v8, v8 quad_perm:[1,0,3,2] row_mask:0xf bank_mask:0xf
  v_add_f32_dpp v36, v36, v36 row_half_mirror row_mask:0xf bank_mask:0x5
  v_add_f32_dpp v36, v40, v40 row_half_mirror row_mask:0xf bank_mask:0xa
  v_add_f32_dpp v37, v37, v37 row_half_mirror row_mask:0xf bank_mask:0x5
  v_add_f32_dpp v37, v41, v41 row_half_mirror row_mask:0xf bank_mask:0xa
  v_add_f32_dpp v38, v38, v38 row_half_mirror row_mask:0xf bank_mask:0x5
  v_add_f32_dpp v38, v42, v42 row_half_mirror row_mask:0xf bank_mask:0xa
  v_add_f32_dpp v39, v39, v39 row_half_mirror row_mask:0xf bank_mask:0x5
  v_add_f32_dpp v39, v43, v43 row_half_mirror row_mask:0xf bank_mask:0xa
  v_add_f32_dpp v44, v44, v44 row_half_mirror row_mask:0xf bank_mask:0x5
  v_add_f32_dpp v44, v48, v48 row_half_mirror row_mask:0xf bank_mask:0xa
  v_add_f32_dpp v45, v45, v45 row_half_mirror row_mask:0xf bank_mask:0x5
  v_add_f32_dpp v45, v49, v49 row_half_mirror row_mask:0xf bank_mask:0xa
  v_add_f32_dpp v46, v46, v46 row_half_mirror row_mask:0xf bank_mask:0x5
  v_add_f32_dpp v46, v50, v50 row_half_mirror row_mask:0xf bank_mask:0xa
  v_add_f32_dpp v47, v47, v47 row_half_mirror row_mask:0xf bank_mask:0x5
  v_add_f32_dpp v47, v51, v51 row_half_mirror row_mask:0xf bank_mask:0xa
  v_add_f32_dpp v52, v52, v52 row_half_mirror row_mask:0xf bank_mask:0x5
  v_add_f32_dpp v52, v56, v56 row_half_mirror row_mask:0xf bank_mask:0xa
  v_add_f32_dpp v53, v53, v53 row_half_mirror row_mask:0xf bank_mask:0x5
  v_add_f32_dpp v53, v57, v57 row_half_mirror row_mask:0xf bank_mask:0xa
  v_add_f32_dpp v54, v54, v54 row_half_mirror row_mask:0xf bank_mask:0x5
  v_add_f32_dpp v54, v58, v58 row_half_mirror row_mask:0xf bank_mask:0xa
  v_add_f32_dpp v55, v55, v55 row_half_mirror row_mask:0xf bank_mask:0x5
  v_add_f32_dpp v55, v59, v59 row_half_mirror row_mask:0xf bank_mask:0xa
  v_add_f32_dpp v8, v8, v8 quad_perm:[2,3,0,1] row_mask:0xf bank_mask:0xf
  v_cndmask_b32 v40, v38, v36, s[86:87]
  v_cndmask_b32 v36, v36, v38, s[86:87]
  v_cndmask_b32 v41, v39, v37, s[86:87]
  v_cndmask_b32 v37, v37, v39, s[86:87]
  v_cndmask_b32 v48, v46, v44, s[86:87]
  v_cndmask_b32 v44, v44, v46, s[86:87]
  v_cndmask_b32 v49, v47, v45, s[86:87]
  v_cndmask_b32 v45, v45, v47, s[86:87]
  v_cndmask_b32 v56, v54, v52, s[86:87]
  v_cndmask_b32 v52, v52, v54, s[86:87]
  v_cndmask_b32 v57, v55, v53, s[86:87]
  v_cndmask_b32 v53, v53, v55, s[86:87]
  v_add_f32_dpp v8, v8, v8 row_half_mirror row_mask:0xf bank_mask:0xf
  v_add_f32_dpp v36, v40, v36 quad_perm:[2,3,0,1] row_mask:0xf bank_mask:0xf
  v_add_f32_dpp v37, v41, v37 quad_perm:[2,3,0,1] row_mask:0xf bank_mask:0xf
  v_add_f32_dpp v44, v48, v44 quad_perm:[2,3,0,1] row_mask:0xf bank_mask:0xf
  v_add_f32_dpp v45, v49, v45 quad_perm:[2,3,0,1] row_mask:0xf bank_mask:0xf
  v_add_f32_dpp v52, v56, v52 quad_perm:[2,3,0,1] row_mask:0xf bank_mask:0xf
  v_add_f32_dpp v53, v57, v53 quad_perm:[2,3,0,1] row_mask:0xf bank_mask:0xf
  v_cndmask_b32 v40, v37, v36, s[88:89]
  v_cndmask_b32 v36, v36, v37, s[88:89]
  v_cndmask_b32 v48, v45, v44, s[88:89]
  v_cndmask_b32 v44, v44, v45, s[88:89]
  v_cndmask_b32 v56, v53, v52, s[88:89]
  v_cndmask_b32 v52, v52, v53, s[88:89]
  v_lshl_add_u32 v4, v1, 4, s9
  s_lshl_b32 s8, s8, 3
  v_add_f32_dpp v28, v40, v36 quad_perm:[1,0,3,2] row_mask:0xf bank_mask:0xf
  v_add_f32_dpp v29, v48, v44 quad_perm:[1,0,3,2] row_mask:0xf bank_mask:0xf
  v_add_f32_dpp v30, v56, v52 quad_perm:[1,0,3,2] row_mask:0xf bank_mask:0xf
  v_mov_b32 v32, v3
  v_mov_b32 v33, v8
  v_mov_b32 v3, s8
  ds_write_b128 v4, v[28:31] offset:4096
  ds_write_b64 v3, v[32:33] offset:2112
  s_add_u32 s42, s42, 1
  s_setpc_b64 s[92:93]
L_merge:
  s_lshl_b32 s9, s68, 3
  v_and_b32 v158, 3, v1
  v_lshl_add_u32 v158, v158, 5, s9
  s_lshl_b32 s9, s68, 10
  v_lshl_add_u32 v159, v1, 4, s9
  ds_read_b64 v[160:161], v158 offset:2112
  ds_read_b128 v[172:175], v159 offset:4096
  ds_read_b128 v[176:179], v159 offset:8192
  ds_read_b128 v[180:183], v159 offset:12288
  ds_read_b128 v[184:187], v159 offset:16384
  s_lshl_b32 s8, s4, 2
  s_add_u32 s8, s8, s68
  s_lshl_b32 s8, s8, 3
  s_add_u32 s8, s8, s5
  s_lshl_b32 s9, s8, 10
  s_add_u32 s9, s9, 1048576
  v_lshl_add_u32 v156, v1, 4, s9
  s_lshl_b32 s9, s8, 7
  s_add_u32 s9, s9, 917504
  v_lshl_add_u32 v157, v1, 4, s9
  s_waitcnt lgkmcnt(4)
  v_mov_b32 v168, v160
  s_nop 1
  v_max_f32_dpp v168, v168, v168 quad_perm:[1,0,3,2] row_mask:0xf bank_mask:0xf
  s_nop 1
  v_max_f32_dpp v168, v168, v168 quad_perm:[2,3,0,1] row_mask:0xf bank_mask:0xf
  v_sub_f32 v162, v160, v168
  v_mul_f32 v162, 0x3fb8aa3b, v162
  v_exp_f32 v162, v162
  s_nop 0
  v_mul_f32 v169, v162, v161
  v_readlane_b32 s64, v162, 0
  v_readlane_b32 s65, v162, 1
  v_add_f32_dpp v169, v169, v169 quad_perm:[1,0,3,2] row_mask:0xf bank_mask:0xf
  v_readlane_b32 s66, v162, 2
  v_readlane_b32 s67, v162, 3
  v_add_f32_dpp v169, v169, v169 quad_perm:[2,3,0,1] row_mask:0xf bank_mask:0xf
  s_waitcnt lgkmcnt(0)
  v_pk_mul_f32 v[164:165], v[172:173], s[64:65] op_sel_hi:[1,0]
  v_mul_f32 v166, s64, v174
  v_bitop3_b32 v170, v168, v169, s78 bitop3:0x96
  v_pk_fma_f32 v[164:165], v[176:177], s[64:65], v[164:165] op_sel:[0,1,0] op_sel_hi:[1,1,1]
  v_fmac_f32 v166, s65, v178
  v_pk_fma_f32 v[164:165], v[180:181], s[66:67], v[164:165] op_sel_hi:[1,0,1]
  v_fmac_f32 v166, s66, v182
  v_pk_fma_f32 v[164:165], v[184:185], s[66:67], v[164:165] op_sel:[0,1,0] op_sel_hi:[1,1,1]
  v_fmac_f32 v166, s67, v186
  v_bitop3_b32 v167, v164, v165, v166 bitop3:0x96
  v_xor_b32 v167, s78, v167
  global_store_dwordx4 v156, v[164:167], s[40:41] sc1
  s_mov_b32 exec_lo, 0xff
  s_mov_b32 exec_hi, 0x0
  global_store_dwordx4 v157, v[168:171], s[40:41] sc1
  s_mov_b64 exec, -1
  s_setpc_b64 s[92:93]
L_last0:
  v_mov_b32 v4, 2048
  s_mov_b64 exec, 1
  ds_add_u32 v4, v6 offset:8
  s_mov_b64 exec, -1
  v_add_f32_dpp v12, v29, v28 row_ror:8 row_mask:0xf bank_mask:0x3
  v_add_f32_dpp v12, v28, v29 row_ror:8 row_mask:0xf bank_mask:0xc
  v_add_f32_dpp v13, v33, v32 row_ror:8 row_mask:0xf bank_mask:0x3
  v_add_f32_dpp v13, v32, v33 row_ror:8 row_mask:0xf bank_mask:0xc
  v_cvt_pk_bf16_f32 v3, v12, v13
  v_lshlrev_b32 v12, 16, v3
  v_and_b32 v13, s15, v3
  v_mul_f32 v12, 0x3d93cd3a, v12
  v_mul_f32 v13, 0x3d93cd3a, v13
  v_cvt_pk_bf16_f32 v3, v12, v13
  v_lshlrev_b32 v12, 16, v3
  v_and_b32 v13, s15, v3
  v_max3_f32 v3, v7, v12, v13
  v_sub_f32 v9, v7, v3
  v_sub_f32 v12, v12, v3
  v_sub_f32 v13, v13, v3
  v_mul_f32 v9, 0x3fb8aa3b, v9
  v_mul_f32 v12, 0x3fb8aa3b, v12
  v_mul_f32 v13, 0x3fb8aa3b, v13
  v_exp_f32 v9, v9
  v_exp_f32 v12, v12
  v_exp_f32 v13, v13
  v_mov_b32 v7, v3
  v_fma_f32 v8, v8, v9, v12
  v_pk_mul_f32 v[36:37], v[36:37], v[8:9] op_sel:[0,1] op_sel_hi:[1,1]
  v_pk_mul_f32 v[38:39], v[38:39], v[8:9] op_sel:[0,1] op_sel_hi:[1,1]
  v_pk_mul_f32 v[40:41], v[40:41], v[8:9] op_sel:[0,1] op_sel_hi:[1,1]
  v_pk_mul_f32 v[42:43], v[42:43], v[8:9] op_sel:[0,1] op_sel_hi:[1,1]
  v_pk_mul_f32 v[44:45], v[44:45], v[8:9] op_sel:[0,1] op_sel_hi:[1,1]
  v_pk_mul_f32 v[46:47], v[46:47], v[8:9] op_sel:[0,1] op_sel_hi:[1,1]
  v_pk_mul_f32 v[48:49], v[48:49], v[8:9] op_sel:[0,1] op_sel_hi:[1,1]
  v_pk_mul_f32 v[50:51], v[50:51], v[8:9] op_sel:[0,1] op_sel_hi:[1,1]
  v_pk_mul_f32 v[52:53], v[52:53], v[8:9] op_sel:[0,1] op_sel_hi:[1,1]
  v_pk_mul_f32 v[54:55], v[54:55], v[8:9] op_sel:[0,1] op_sel_hi:[1,1]
  v_pk_mul_f32 v[56:57], v[56:57], v[8:9] op_sel:[0,1] op_sel_hi:[1,1]
  v_pk_mul_f32 v[58:59], v[58:59], v[8:9] op_sel:[0,1] op_sel_hi:[1,1]
  v_add_f32 v8, v8, v13
  s_waitcnt vmcnt(12)
  v_lshlrev_b32 v28, 16, v84
  v_and_b32 v29, s15, v84
  v_lshlrev_b32 v30, 16, v85
  v_and_b32 v31, s15, v85
  v_lshlrev_b32 v32, 16, v86
  v_and_b32 v33, s15, v86
  v_pk_fma_f32 v[36:37], v[28:29], v[12:13], v[36:37] op_sel_hi:[1,0,1]
  v_lshlrev_b32 v34, 16, v87
  v_and_b32 v35, s15, v87
  v_pk_fma_f32 v[38:39], v[30:31], v[12:13], v[38:39] op_sel_hi:[1,0,1]
  v_lshlrev_b32 v28, 16, v88
  v_and_b32 v29, s15, v88
  v_pk_fma_f32 v[40:41], v[32:33], v[12:13], v[40:41] op_sel_hi:[1,0,1]
  v_lshlrev_b32 v30, 16, v89
  v_and_b32 v31, s15, v89
  v_pk_fma_f32 v[42:43], v[34:35], v[12:13], v[42:43] op_sel_hi:[1,0,1]
  v_lshlrev_b32 v32, 16, v90
  v_and_b32 v33, s15, v90
  v_pk_fma_f32 v[44:45], v[28:29], v[12:13], v[44:45] op_sel_hi:[1,0,1]
  v_lshlrev_b32 v34, 16, v91
  v_and_b32 v35, s15, v91
  v_pk_fma_f32 v[46:47], v[30:31], v[12:13], v[46:47] op_sel_hi:[1,0,1]
  v_lshlrev_b32 v28, 16, v92
  v_and_b32 v29, s15, v92
  v_pk_fma_f32 v[48:49], v[32:33], v[12:13], v[48:49] op_sel_hi:[1,0,1]
  v_lshlrev_b32 v30, 16, v93
  v_and_b32 v31, s15, v93
  v_pk_fma_f32 v[50:51], v[34:35], v[12:13], v[50:51] op_sel_hi:[1,0,1]
  v_lshlrev_b32 v32, 16, v94
  v_and_b32 v33, s15, v94
  v_pk_fma_f32 v[52:53], v[28:29], v[12:13], v[52:53] op_sel_hi:[1,0,1]
  v_lshlrev_b32 v34, 16, v95
  v_and_b32 v35, s15, v95
  v_pk_fma_f32 v[54:55], v[30:31], v[12:13], v[54:55] op_sel_hi:[1,0,1]
  v_lshlrev_b32 v28, 16, v96
  v_and_b32 v29, s15, v96
  v_pk_fma_f32 v[56:57], v[32:33], v[12:13], v[56:57] op_sel_hi:[1,0,1]
  v_lshlrev_b32 v30, 16, v97
  v_and_b32 v31, s15, v97
  v_pk_fma_f32 v[58:59], v[34:35], v[12:13], v[58:59] op_sel_hi:[1,0,1]
  v_lshlrev_b32 v32, 16, v98
  v_and_b32 v33, s15, v98
  v_pk_fma_f32 v[36:37], v[28:29], v[12:13], v[36:37] op_sel:[0,1,0] op_sel_hi:[1,1,1]
  v_lshlrev_b32 v34, 16, v99
  v_and_b32 v35, s15, v99
  v_pk_fma_f32 v[38:39], v[30:31], v[12:13], v[38:39] op_sel:[0,1,0] op_sel_hi:[1,1,1]
  v_lshlrev_b32 v28, 16, v100
  v_and_b32 v29, s15, v100
  v_pk_fma_f32 v[40:41], v[32:33], v[12:13], v[40:41] op_sel:[0,1,0] op_sel_hi:[1,1,1]
  v_lshlrev_b32 v30, 16, v101
  v_and_b32 v31, s15, v101
  v_pk_fma_f32 v[42:43], v[34:35], v[12:13], v[42:43] op_sel:[0,1,0] op_sel_hi:[1,1,1]
  v_lshlrev_b32 v32, 16, v102
  v_and_b32 v33, s15, v102
  v_pk_fma_f32 v[44:45], v[28:29], v[12:13], v[44:45] op_sel:[0,1,0] op_sel_hi:[1,1,1]
  v_lshlrev_b32 v34, 16, v103
  v_and_b32 v35, s15, v103
  v_pk_fma_f32 v[46:47], v[30:31], v[12:13], v[46:47] op_sel:[0,1,0] op_sel_hi:[1,1,1]
  v_lshlrev_b32 v28, 16, v104
  v_and_b32 v29, s15, v104
  v_pk_fma_f32 v[48:49], v[32:33], v[12:13], v[48:49] op_sel:[0,1,0] op_sel_hi:[1,1,1]
  v_lshlrev_b32 v30, 16, v105
  v_and_b32 v31, s15, v105
  v_pk_fma_f32 v[50:51], v[34:35], v[12:13], v[50:51] op_sel:[0,1,0] op_sel_hi:[1,1,1]
  v_lshlrev_b32 v32, 16, v106
  v_and_b32 v33, s15, v106
  v_pk_fma_f32 v[52:53], v[28:29], v[12:13], v[52:53] op_sel:[0,1,0] op_sel_hi:[1,1,1]
  v_lshlrev_b32 v34, 16, v107
  v_and_b32 v35, s15, v107
  v_pk_fma_f32 v[54:55], v[30:31], v[12:13], v[54:55] op_sel:[0,1,0] op_sel_hi:[1,1,1]
  v_pk_fma_f32 v[56:57], v[32:33], v[12:13], v[56:57] op_sel:[0,1,0] op_sel_hi:[1,1,1]
  v_pk_fma_f32 v[58:59], v[34:35], v[12:13], v[58:59] op_sel:[0,1,0] op_sel_hi:[1,1,1]
  s_waitcnt vmcnt(6)
  v_mfma_f32_16x16x32_bf16 v[28:31], v[16:19], v[108:111], 0
  v_mfma_f32_16x16x32_bf16 v[32:35], v[16:19], v[120:123], 0
  v_mfma_f32_16x16x32_bf16 v[28:31], v[20:23], v[112:115], v[28:31]
  v_mfma_f32_16x16x32_bf16 v[32:35], v[20:23], v[124:127], v[32:35]
  v_mfma_f32_16x16x32_bf16 v[28:31], v[24:27], v[116:119], v[28:31]
  v_mfma_f32_16x16x32_bf16 v[32:35], v[24:27], v[128:131], v[32:35]
  s_nop 7
  v_add_f32_dpp v12, v29, v28 row_ror:8 row_mask:0xf bank_mask:0x3
  v_add_f32_dpp v12, v28, v29 row_ror:8 row_mask:0xf bank_mask:0xc
  v_add_f32_dpp v13, v33, v32 row_ror:8 row_mask:0xf bank_mask:0x3
  v_add_f32_dpp v13, v32, v33 row_ror:8 row_mask:0xf bank_mask:0xc
  v_cvt_pk_bf16_f32 v3, v12, v13
  v_lshlrev_b32 v12, 16, v3
  v_and_b32 v13, s15, v3
  v_mul_f32 v12, 0x3d93cd3a, v12
  v_mul_f32 v13, 0x3d93cd3a, v13
  v_cvt_pk_bf16_f32 v3, v12, v13
  v_lshlrev_b32 v12, 16, v3
  v_and_b32 v13, s15, v3
  v_max3_f32 v3, v7, v12, v13
  v_sub_f32 v9, v7, v3
  v_sub_f32 v12, v12, v3
  v_sub_f32 v13, v13, v3
  v_mul_f32 v9, 0x3fb8aa3b, v9
  v_mul_f32 v12, 0x3fb8aa3b, v12
  v_mul_f32 v13, 0x3fb8aa3b, v13
  v_exp_f32 v9, v9
  v_exp_f32 v12, v12
  v_exp_f32 v13, v13
  v_mov_b32 v7, v3
  v_fma_f32 v8, v8, v9, v12
  v_pk_mul_f32 v[36:37], v[36:37], v[8:9] op_sel:[0,1] op_sel_hi:[1,1]
  v_pk_mul_f32 v[38:39], v[38:39], v[8:9] op_sel:[0,1] op_sel_hi:[1,1]
  v_pk_mul_f32 v[40:41], v[40:41], v[8:9] op_sel:[0,1] op_sel_hi:[1,1]
  v_pk_mul_f32 v[42:43], v[42:43], v[8:9] op_sel:[0,1] op_sel_hi:[1,1]
  v_pk_mul_f32 v[44:45], v[44:45], v[8:9] op_sel:[0,1] op_sel_hi:[1,1]
  v_pk_mul_f32 v[46:47], v[46:47], v[8:9] op_sel:[0,1] op_sel_hi:[1,1]
  v_pk_mul_f32 v[48:49], v[48:49], v[8:9] op_sel:[0,1] op_sel_hi:[1,1]
  v_pk_mul_f32 v[50:51], v[50:51], v[8:9] op_sel:[0,1] op_sel_hi:[1,1]
  v_pk_mul_f32 v[52:53], v[52:53], v[8:9] op_sel:[0,1] op_sel_hi:[1,1]
  v_pk_mul_f32 v[54:55], v[54:55], v[8:9] op_sel:[0,1] op_sel_hi:[1,1]
  v_pk_mul_f32 v[56:57], v[56:57], v[8:9] op_sel:[0,1] op_sel_hi:[1,1]
  v_pk_mul_f32 v[58:59], v[58:59], v[8:9] op_sel:[0,1] op_sel_hi:[1,1]
  v_add_f32 v8, v8, v13
  s_cmp_eq_u32 s85, 3
  s_cbranch_scc1 L_w3_0
  v_mov_b32 v4, 2048
  s_mov_b32 s79, 8388608
L_f12_0:
  ds_read_b32 v3, v4 offset:24
  s_waitcnt lgkmcnt(0)
  v_readfirstlane_b32 s8, v3
  s_sub_u32 s79, s79, 1
  s_cselect_b32 s8, 12, s8
  s_cmp_ge_u32 s8, 12
  s_cbranch_scc1 L_f12_0ok
  s_sleep 1
  s_branch L_f12_0
L_f12_0ok:
  s_mov_b32 s68, s85
  s_call_b64 s[92:93], L_merge
  s_waitcnt vmcnt(2)
  s_branch L_w4_0
L_w3_0:
  s_waitcnt vmcnt(0)
L_w4_0:
  v_lshlrev_b32 v28, 16, v132
  v_and_b32 v29, s15, v132
  v_lshlrev_b32 v30, 16, v133
  v_and_b32 v31, s15, v133
  v_lshlrev_b32 v32, 16, v134
  v_and_b32 v33, s15, v134
  v_pk_fma_f32 v[36:37], v[28:29], v[12:13], v[36:37] op_sel_hi:[1,0,1]
  v_lshlrev_b32 v34, 16, v135
  v_and_b32 v35, s15, v135
  v_pk_fma_f32 v[38:39], v[30:31], v[12:13], v[38:39] op_sel_hi:[1,0,1]
  v_lshlrev_b32 v28, 16, v136
  v_and_b32 v29, s15, v136
  v_pk_fma_f32 v[40:41], v[32:33], v[12:13], v[40:41] op_sel_hi:[1,0,1]
  v_lshlrev_b32 v30, 16, v137
  v_and_b32 v31, s15, v137
  v_pk_fma_f32 v[42:43], v[34:35], v[12:13], v[42:43] op_sel_hi:[1,0,1]
  v_lshlrev_b32 v32, 16, v138
  v_and_b32 v33, s15, v138
  v_pk_fma_f32 v[44:45], v[28:29], v[12:13], v[44:45] op_sel_hi:[1,0,1]
  v_lshlrev_b32 v34, 16, v139
  v_and_b32 v35, s15, v139
  v_pk_fma_f32 v[46:47], v[30:31], v[12:13], v[46:47] op_sel_hi:[1,0,1]
  v_lshlrev_b32 v28, 16, v140
  v_and_b32 v29, s15, v140
  v_pk_fma_f32 v[48:49], v[32:33], v[12:13], v[48:49] op_sel_hi:[1,0,1]
  v_lshlrev_b32 v30, 16, v141
  v_and_b32 v31, s15, v141
  v_pk_fma_f32 v[50:51], v[34:35], v[12:13], v[50:51] op_sel_hi:[1,0,1]
  v_lshlrev_b32 v32, 16, v142
  v_and_b32 v33, s15, v142
  v_pk_fma_f32 v[52:53], v[28:29], v[12:13], v[52:53] op_sel_hi:[1,0,1]
  v_lshlrev_b32 v34, 16, v143
  v_and_b32 v35, s15, v143
  v_pk_fma_f32 v[54:55], v[30:31], v[12:13], v[54:55] op_sel_hi:[1,0,1]
  v_lshlrev_b32 v28, 16, v144
  v_and_b32 v29, s15, v144
  v_pk_fma_f32 v[56:57], v[32:33], v[12:13], v[56:57] op_sel_hi:[1,0,1]
  v_lshlrev_b32 v30, 16, v145
  v_and_b32 v31, s15, v145
  v_pk_fma_f32 v[58:59], v[34:35], v[12:13], v[58:59] op_sel_hi:[1,0,1]
  v_lshlrev_b32 v32, 16, v146
  v_and_b32 v33, s15, v146
  v_pk_fma_f32 v[36:37], v[28:29], v[12:13], v[36:37] op_sel:[0,1,0] op_sel_hi:[1,1,1]
  v_lshlrev_b32 v34, 16, v147
  v_and_b32 v35, s15, v147
  v_pk_fma_f32 v[38:39], v[30:31], v[12:13], v[38:39] op_sel:[0,1,0] op_sel_hi:[1,1,1]
  v_lshlrev_b32 v28, 16, v148
  v_and_b32 v29, s15, v148
  v_pk_fma_f32 v[40:41], v[32:33], v[12:13], v[40:41] op_sel:[0,1,0] op_sel_hi:[1,1,1]
  v_lshlrev_b32 v30, 16, v149
  v_and_b32 v31, s15, v149
  v_pk_fma_f32 v[42:43], v[34:35], v[12:13], v[42:43] op_sel:[0,1,0] op_sel_hi:[1,1,1]
  v_lshlrev_b32 v32, 16, v150
  v_and_b32 v33, s15, v150
  v_pk_fma_f32 v[44:45], v[28:29], v[12:13], v[44:45] op_sel:[0,1,0] op_sel_hi:[1,1,1]
  v_lshlrev_b32 v34, 16, v151
  v_and_b32 v35, s15, v151
  v_pk_fma_f32 v[46:47], v[30:31], v[12:13], v[46:47] op_sel:[0,1,0] op_sel_hi:[1,1,1]
  v_lshlrev_b32 v28, 16, v152
  v_and_b32 v29, s15, v152
  v_pk_fma_f32 v[48:49], v[32:33], v[12:13], v[48:49] op_sel:[0,1,0] op_sel_hi:[1,1,1]
  v_lshlrev_b32 v30, 16, v153
  v_and_b32 v31, s15, v153
  v_pk_fma_f32 v[50:51], v[34:35], v[12:13], v[50:51] op_sel:[0,1,0] op_sel_hi:[1,1,1]
  v_lshlrev_b32 v32, 16, v154
  v_and_b32 v33, s15, v154
  v_pk_fma_f32 v[52:53], v[28:29], v[12:13], v[52:53] op_sel:[0,1,0] op_sel_hi:[1,1,1]
  v_lshlrev_b32 v34, 16, v155
  v_and_b32 v35, s15, v155
  v_pk_fma_f32 v[54:55], v[30:31], v[12:13], v[54:55] op_sel:[0,1,0] op_sel_hi:[1,1,1]
  v_pk_fma_f32 v[56:57], v[32:33], v[12:13], v[56:57] op_sel:[0,1,0] op_sel_hi:[1,1,1]
  v_pk_fma_f32 v[58:59], v[34:35], v[12:13], v[58:59] op_sel:[0,1,0] op_sel_hi:[1,1,1]
  s_branch L_fin
L_last1:
  v_mov_b32 v4, 2048
  s_mov_b64 exec, 1
  ds_add_u32 v4, v6 offset:8
  s_mov_b64 exec, -1
  v_add_f32_dpp v12, v29, v28 row_ror:8 row_mask:0xf bank_mask:0x3
  v_add_f32_dpp v12, v28, v29 row_ror:8 row_mask:0xf bank_mask:0xc
  v_add_f32_dpp v13, v33, v32 row_ror:8 row_mask:0xf bank_mask:0x3
  v_add_f32_dpp v13, v32, v33 row_ror:8 row_mask:0xf bank_mask:0xc
  v_cvt_pk_bf16_f32 v3, v12, v13
  v_lshlrev_b32 v12, 16, v3
  v_and_b32 v13, s15, v3
  v_mul_f32 v12, 0x3d93cd3a, v12
  v_mul_f32 v13, 0x3d93cd3a, v13
  v_cvt_pk_bf16_f32 v3, v12, v13
  v_lshlrev_b32 v12, 16, v3
  v_and_b32 v13, s15, v3
  v_max3_f32 v3, v7, v12, v13
  v_sub_f32 v9, v7, v3
  v_sub_f32 v12, v12, v3
  v_sub_f32 v13, v13, v3
  v_mul_f32 v9, 0x3fb8aa3b, v9
  v_mul_f32 v12, 0x3fb8aa3b, v12
  v_mul_f32 v13, 0x3fb8aa3b, v13
  v_exp_f32 v9, v9
  v_exp_f32 v12, v12
  v_exp_f32 v13, v13
  v_mov_b32 v7, v3
  v_fma_f32 v8, v8, v9, v12
  v_pk_mul_f32 v[36:37], v[36:37], v[8:9] op_sel:[0,1] op_sel_hi:[1,1]
  v_pk_mul_f32 v[38:39], v[38:39], v[8:9] op_sel:[0,1] op_sel_hi:[1,1]
  v_pk_mul_f32 v[40:41], v[40:41], v[8:9] op_sel:[0,1] op_sel_hi:[1,1]
  v_pk_mul_f32 v[42:43], v[42:43], v[8:9] op_sel:[0,1] op_sel_hi:[1,1]
  v_pk_mul_f32 v[44:45], v[44:45], v[8:9] op_sel:[0,1] op_sel_hi:[1,1]
  v_pk_mul_f32 v[46:47], v[46:47], v[8:9] op_sel:[0,1] op_sel_hi:[1,1]
  v_pk_mul_f32 v[48:49], v[48:49], v[8:9] op_sel:[0,1] op_sel_hi:[1,1]
  v_pk_mul_f32 v[50:51], v[50:51], v[8:9] op_sel:[0,1] op_sel_hi:[1,1]
  v_pk_mul_f32 v[52:53], v[52:53], v[8:9] op_sel:[0,1] op_sel_hi:[1,1]
  v_pk_mul_f32 v[54:55], v[54:55], v[8:9] op_sel:[0,1] op_sel_hi:[1,1]
  v_pk_mul_f32 v[56:57], v[56:57], v[8:9] op_sel:[0,1] op_sel_hi:[1,1]
  v_pk_mul_f32 v[58:59], v[58:59], v[8:9] op_sel:[0,1] op_sel_hi:[1,1]
  v_add_f32 v8, v8, v13
  s_waitcnt vmcnt(12)
  v_lshlrev_b32 v28, 16, v132
  v_and_b32 v29, s15, v132
  v_lshlrev_b32 v30, 16, v133
  v_and_b32 v31, s15, v133
  v_lshlrev_b32 v32, 16, v134
  v_and_b32 v33, s15, v134
  v_pk_fma_f32 v[36:37], v[28:29], v[12:13], v[36:37] op_sel_hi:[1,0,1]
  v_lshlrev_b32 v34, 16, v135
  v_and_b32 v35, s15, v135
  v_pk_fma_f32 v[38:39], v[30:31], v[12:13], v[38:39] op_sel_hi:[1,0,1]
  v_lshlrev_b32 v28, 16, v136
  v_and_b32 v29, s15, v136
  v_pk_fma_f32 v[40:41], v[32:33], v[12:13], v[40:41] op_sel_hi:[1,0,1]
  v_lshlrev_b32 v30, 16, v137
  v_and_b32 v31, s15, v137
  v_pk_fma_f32 v[42:43], v[34:35], v[12:13], v[42:43] op_sel_hi:[1,0,1]
  v_lshlrev_b32 v32, 16, v138
  v_and_b32 v33, s15, v138
  v_pk_fma_f32 v[44:45], v[28:29], v[12:13], v[44:45] op_sel_hi:[1,0,1]
  v_lshlrev_b32 v34, 16, v139
  v_and_b32 v35, s15, v139
  v_pk_fma_f32 v[46:47], v[30:31], v[12:13], v[46:47] op_sel_hi:[1,0,1]
  v_lshlrev_b32 v28, 16, v140
  v_and_b32 v29, s15, v140
  v_pk_fma_f32 v[48:49], v[32:33], v[12:13], v[48:49] op_sel_hi:[1,0,1]
  v_lshlrev_b32 v30, 16, v141
  v_and_b32 v31, s15, v141
  v_pk_fma_f32 v[50:51], v[34:35], v[12:13], v[50:51] op_sel_hi:[1,0,1]
  v_lshlrev_b32 v32, 16, v142
  v_and_b32 v33, s15, v142
  v_pk_fma_f32 v[52:53], v[28:29], v[12:13], v[52:53] op_sel_hi:[1,0,1]
  v_lshlrev_b32 v34, 16, v143
  v_and_b32 v35, s15, v143
  v_pk_fma_f32 v[54:55], v[30:31], v[12:13], v[54:55] op_sel_hi:[1,0,1]
  v_lshlrev_b32 v28, 16, v144
  v_and_b32 v29, s15, v144
  v_pk_fma_f32 v[56:57], v[32:33], v[12:13], v[56:57] op_sel_hi:[1,0,1]
  v_lshlrev_b32 v30, 16, v145
  v_and_b32 v31, s15, v145
  v_pk_fma_f32 v[58:59], v[34:35], v[12:13], v[58:59] op_sel_hi:[1,0,1]
  v_lshlrev_b32 v32, 16, v146
  v_and_b32 v33, s15, v146
  v_pk_fma_f32 v[36:37], v[28:29], v[12:13], v[36:37] op_sel:[0,1,0] op_sel_hi:[1,1,1]
  v_lshlrev_b32 v34, 16, v147
  v_and_b32 v35, s15, v147
  v_pk_fma_f32 v[38:39], v[30:31], v[12:13], v[38:39] op_sel:[0,1,0] op_sel_hi:[1,1,1]
  v_lshlrev_b32 v28, 16, v148
  v_and_b32 v29, s15, v148
  v_pk_fma_f32 v[40:41], v[32:33], v[12:13], v[40:41] op_sel:[0,1,0] op_sel_hi:[1,1,1]
  v_lshlrev_b32 v30, 16, v149
  v_and_b32 v31, s15, v149
  v_pk_fma_f32 v[42:43], v[34:35], v[12:13], v[42:43] op_sel:[0,1,0] op_sel_hi:[1,1,1]
  v_lshlrev_b32 v32, 16, v150
  v_and_b32 v33, s15, v150
  v_pk_fma_f32 v[44:45], v[28:29], v[12:13], v[44:45] op_sel:[0,1,0] op_sel_hi:[1,1,1]
  v_lshlrev_b32 v34, 16, v151
  v_and_b32 v35, s15, v151
  v_pk_fma_f32 v[46:47], v[30:31], v[12:13], v[46:47] op_sel:[0,1,0] op_sel_hi:[1,1,1]
  v_lshlrev_b32 v28, 16, v152
  v_and_b32 v29, s15, v152
  v_pk_fma_f32 v[48:49], v[32:33], v[12:13], v[48:49] op_sel:[0,1,0] op_sel_hi:[1,1,1]
  v_lshlrev_b32 v30, 16, v153
  v_and_b32 v31, s15, v153
  v_pk_fma_f32 v[50:51], v[34:35], v[12:13], v[50:51] op_sel:[0,1,0] op_sel_hi:[1,1,1]
  v_lshlrev_b32 v32, 16, v154
  v_and_b32 v33, s15, v154
  v_pk_fma_f32 v[52:53], v[28:29], v[12:13], v[52:53] op_sel:[0,1,0] op_sel_hi:[1,1,1]
  v_lshlrev_b32 v34, 16, v155
  v_and_b32 v35, s15, v155
  v_pk_fma_f32 v[54:55], v[30:31], v[12:13], v[54:55] op_sel:[0,1,0] op_sel_hi:[1,1,1]
  v_pk_fma_f32 v[56:57], v[32:33], v[12:13], v[56:57] op_sel:[0,1,0] op_sel_hi:[1,1,1]
  v_pk_fma_f32 v[58:59], v[34:35], v[12:13], v[58:59] op_sel:[0,1,0] op_sel_hi:[1,1,1]
  s_waitcnt vmcnt(6)
  v_mfma_f32_16x16x32_bf16 v[28:31], v[16:19], v[60:63], 0
  v_mfma_f32_16x16x32_bf16 v[32:35], v[16:19], v[72:75], 0
  v_mfma_f32_16x16x32_bf16 v[28:31], v[20:23], v[64:67], v[28:31]
  v_mfma_f32_16x16x32_bf16 v[32:35], v[20:23], v[76:79], v[32:35]
  v_mfma_f32_16x16x32_bf16 v[28:31], v[24:27], v[68:71], v[28:31]
  v_mfma_f32_16x16x32_bf16 v[32:35], v[24:27], v[80:83], v[32:35]
  s_nop 7
  v_add_f32_dpp v12, v29, v28 row_ror:8 row_mask:0xf bank_mask:0x3
  v_add_f32_dpp v12, v28, v29 row_ror:8 row_mask:0xf bank_mask:0xc
  v_add_f32_dpp v13, v33, v32 row_ror:8 row_mask:0xf bank_mask:0x3
  v_add_f32_dpp v13, v32, v33 row_ror:8 row_mask:0xf bank_mask:0xc
  v_cvt_pk_bf16_f32 v3, v12, v13
  v_lshlrev_b32 v12, 16, v3
  v_and_b32 v13, s15, v3
  v_mul_f32 v12, 0x3d93cd3a, v12
  v_mul_f32 v13, 0x3d93cd3a, v13
  v_cvt_pk_bf16_f32 v3, v12, v13
  v_lshlrev_b32 v12, 16, v3
  v_and_b32 v13, s15, v3
  v_max3_f32 v3, v7, v12, v13
  v_sub_f32 v9, v7, v3
  v_sub_f32 v12, v12, v3
  v_sub_f32 v13, v13, v3
  v_mul_f32 v9, 0x3fb8aa3b, v9
  v_mul_f32 v12, 0x3fb8aa3b, v12
  v_mul_f32 v13, 0x3fb8aa3b, v13
  v_exp_f32 v9, v9
  v_exp_f32 v12, v12
  v_exp_f32 v13, v13
  v_mov_b32 v7, v3
  v_fma_f32 v8, v8, v9, v12
  v_pk_mul_f32 v[36:37], v[36:37], v[8:9] op_sel:[0,1] op_sel_hi:[1,1]
  v_pk_mul_f32 v[38:39], v[38:39], v[8:9] op_sel:[0,1] op_sel_hi:[1,1]
  v_pk_mul_f32 v[40:41], v[40:41], v[8:9] op_sel:[0,1] op_sel_hi:[1,1]
  v_pk_mul_f32 v[42:43], v[42:43], v[8:9] op_sel:[0,1] op_sel_hi:[1,1]
  v_pk_mul_f32 v[44:45], v[44:45], v[8:9] op_sel:[0,1] op_sel_hi:[1,1]
  v_pk_mul_f32 v[46:47], v[46:47], v[8:9] op_sel:[0,1] op_sel_hi:[1,1]
  v_pk_mul_f32 v[48:49], v[48:49], v[8:9] op_sel:[0,1] op_sel_hi:[1,1]
  v_pk_mul_f32 v[50:51], v[50:51], v[8:9] op_sel:[0,1] op_sel_hi:[1,1]
  v_pk_mul_f32 v[52:53], v[52:53], v[8:9] op_sel:[0,1] op_sel_hi:[1,1]
  v_pk_mul_f32 v[54:55], v[54:55], v[8:9] op_sel:[0,1] op_sel_hi:[1,1]
  v_pk_mul_f32 v[56:57], v[56:57], v[8:9] op_sel:[0,1] op_sel_hi:[1,1]
  v_pk_mul_f32 v[58:59], v[58:59], v[8:9] op_sel:[0,1] op_sel_hi:[1,1]
  v_add_f32 v8, v8, v13
  s_cmp_eq_u32 s85, 3
  s_cbranch_scc1 L_w3_1
  v_mov_b32 v4, 2048
  s_mov_b32 s79, 8388608
L_f12_1:
  ds_read_b32 v3, v4 offset:24
  s_waitcnt lgkmcnt(0)
  v_readfirstlane_b32 s8, v3
  s_sub_u32 s79, s79, 1
  s_cselect_b32 s8, 12, s8
  s_cmp_ge_u32 s8, 12
  s_cbranch_scc1 L_f12_1ok
  s_sleep 1
  s_branch L_f12_1
L_f12_1ok:
  s_mov_b32 s68, s85
  s_call_b64 s[92:93], L_merge
  s_waitcnt vmcnt(2)
  s_branch L_w4_1
L_w3_1:
  s_waitcnt vmcnt(0)
L_w4_1:
  v_lshlrev_b32 v28, 16, v84
  v_and_b32 v29, s15, v84
  v_lshlrev_b32 v30, 16, v85
  v_and_b32 v31, s15, v85
  v_lshlrev_b32 v32, 16, v86
  v_and_b32 v33, s15, v86
  v_pk_fma_f32 v[36:37], v[28:29], v[12:13], v[36:37] op_sel_hi:[1,0,1]
  v_lshlrev_b32 v34, 16, v87
  v_and_b32 v35, s15, v87
  v_pk_fma_f32 v[38:39], v[30:31], v[12:13], v[38:39] op_sel_hi:[1,0,1]
  v_lshlrev_b32 v28, 16, v88
  v_and_b32 v29, s15, v88
  v_pk_fma_f32 v[40:41], v[32:33], v[12:13], v[40:41] op_sel_hi:[1,0,1]
  v_lshlrev_b32 v30, 16, v89
  v_and_b32 v31, s15, v89
  v_pk_fma_f32 v[42:43], v[34:35], v[12:13], v[42:43] op_sel_hi:[1,0,1]
  v_lshlrev_b32 v32, 16, v90
  v_and_b32 v33, s15, v90
  v_pk_fma_f32 v[44:45], v[28:29], v[12:13], v[44:45] op_sel_hi:[1,0,1]
  v_lshlrev_b32 v34, 16, v91
  v_and_b32 v35, s15, v91
  v_pk_fma_f32 v[46:47], v[30:31], v[12:13], v[46:47] op_sel_hi:[1,0,1]
  v_lshlrev_b32 v28, 16, v92
  v_and_b32 v29, s15, v92
  v_pk_fma_f32 v[48:49], v[32:33], v[12:13], v[48:49] op_sel_hi:[1,0,1]
  v_lshlrev_b32 v30, 16, v93
  v_and_b32 v31, s15, v93
  v_pk_fma_f32 v[50:51], v[34:35], v[12:13], v[50:51] op_sel_hi:[1,0,1]
  v_lshlrev_b32 v32, 16, v94
  v_and_b32 v33, s15, v94
  v_pk_fma_f32 v[52:53], v[28:29], v[12:13], v[52:53] op_sel_hi:[1,0,1]
  v_lshlrev_b32 v34, 16, v95
  v_and_b32 v35, s15, v95
  v_pk_fma_f32 v[54:55], v[30:31], v[12:13], v[54:55] op_sel_hi:[1,0,1]
  v_lshlrev_b32 v28, 16, v96
  v_and_b32 v29, s15, v96
  v_pk_fma_f32 v[56:57], v[32:33], v[12:13], v[56:57] op_sel_hi:[1,0,1]
  v_lshlrev_b32 v30, 16, v97
  v_and_b32 v31, s15, v97
  v_pk_fma_f32 v[58:59], v[34:35], v[12:13], v[58:59] op_sel_hi:[1,0,1]
  v_lshlrev_b32 v32, 16, v98
  v_and_b32 v33, s15, v98
  v_pk_fma_f32 v[36:37], v[28:29], v[12:13], v[36:37] op_sel:[0,1,0] op_sel_hi:[1,1,1]
  v_lshlrev_b32 v34, 16, v99
  v_and_b32 v35, s15, v99
  v_pk_fma_f32 v[38:39], v[30:31], v[12:13], v[38:39] op_sel:[0,1,0] op_sel_hi:[1,1,1]
  v_lshlrev_b32 v28, 16, v100
  v_and_b32 v29, s15, v100
  v_pk_fma_f32 v[40:41], v[32:33], v[12:13], v[40:41] op_sel:[0,1,0] op_sel_hi:[1,1,1]
  v_lshlrev_b32 v30, 16, v101
  v_and_b32 v31, s15, v101
  v_pk_fma_f32 v[42:43], v[34:35], v[12:13], v[42:43] op_sel:[0,1,0] op_sel_hi:[1,1,1]
  v_lshlrev_b32 v32, 16, v102
  v_and_b32 v33, s15, v102
  v_pk_fma_f32 v[44:45], v[28:29], v[12:13], v[44:45] op_sel:[0,1,0] op_sel_hi:[1,1,1]
  v_lshlrev_b32 v34, 16, v103
  v_and_b32 v35, s15, v103
  v_pk_fma_f32 v[46:47], v[30:31], v[12:13], v[46:47] op_sel:[0,1,0] op_sel_hi:[1,1,1]
  v_lshlrev_b32 v28, 16, v104
  v_and_b32 v29, s15, v104
  v_pk_fma_f32 v[48:49], v[32:33], v[12:13], v[48:49] op_sel:[0,1,0] op_sel_hi:[1,1,1]
  v_lshlrev_b32 v30, 16, v105
  v_and_b32 v31, s15, v105
  v_pk_fma_f32 v[50:51], v[34:35], v[12:13], v[50:51] op_sel:[0,1,0] op_sel_hi:[1,1,1]
  v_lshlrev_b32 v32, 16, v106
  v_and_b32 v33, s15, v106
  v_pk_fma_f32 v[52:53], v[28:29], v[12:13], v[52:53] op_sel:[0,1,0] op_sel_hi:[1,1,1]
  v_lshlrev_b32 v34, 16, v107
  v_and_b32 v35, s15, v107
  v_pk_fma_f32 v[54:55], v[30:31], v[12:13], v[54:55] op_sel:[0,1,0] op_sel_hi:[1,1,1]
  v_pk_fma_f32 v[56:57], v[32:33], v[12:13], v[56:57] op_sel:[0,1,0] op_sel_hi:[1,1,1]
  v_pk_fma_f32 v[58:59], v[34:35], v[12:13], v[58:59] op_sel:[0,1,0] op_sel_hi:[1,1,1]
L_fin:
  s_call_b64 s[92:93], L_flush
  v_mov_b32 v9, 2048
  s_mov_b64 exec, 1
  ds_add_rtn_u32 v8, v9, v6 offset:12
  s_mov_b64 exec, -1
  s_mov_b32 s68, 3
  s_waitcnt lgkmcnt(0)
  v_readfirstlane_b32 s8, v8
  s_nop 2
  s_cmp_eq_u32 s8, 3
  s_cbranch_scc0 L_nomerge
  s_call_b64 s[92:93], L_merge
L_nomerge:
L_end:
  s_endpgm
.section .rodata,"a"
.p2align 6
.amdhsa_kernel parallel_sum__gqa_block_cached__dense_activation_squared_relu__decode_kernel
  .amdhsa_next_free_vgpr 256
  .amdhsa_next_free_sgpr 102
  .amdhsa_accum_offset 256
  .amdhsa_group_segment_fixed_size 0
  .amdhsa_kernarg_size 104
  .amdhsa_user_sgpr_count 2
  .amdhsa_user_sgpr_kernarg_segment_ptr 1
  .amdhsa_system_sgpr_workgroup_id_x 1
  .amdhsa_float_denorm_mode_32 3
.end_amdhsa_kernel
```
